```python
import torch

def _softmax(x, axis=-1):
    return torch.softmax(x, dim=axis)
def _gelu(x):
    return torch.nn.functional.gelu(x, approximate="tanh")
def _silu(x):
    return torch.nn.functional.silu(x)
def _sigmoid(x):
    return torch.sigmoid(x)
def _layernorm(x, axis=-1, eps=1e-5):
    m = x.mean(dim=axis, keepdim=True)
    v = x.var(dim=axis, keepdim=True, unbiased=False)
    return (x - m) / torch.sqrt(v + eps)
def _scatter_add(tgt, idx, src, axis=0):
    return tgt.clone().index_add_(axis, idx, src)
def _segment_sum(src, seg, n):
    out = torch.zeros((n,) + src.shape[1:], dtype=src.dtype)
    return out.index_add_(0, seg, src)
def _pad(x, pw):
    flat = tuple(v for pair in reversed(pw) for v in pair)
    return torch.nn.functional.pad(x, flat)

kernel_name = 'concat_heads__ssm_conv_s5__grouped_kv_mqa__prompt'

def setup_inputs():

    _w = (lambda a: (lambda t: t.to(torch.bfloat16) if t.is_floating_point() else t)(torch.as_tensor(a)))
    def _A_setup():
        B, S, D = 1, 2048, 512
        P = D
        Lambda_re = -0.5 * (lambda _x: torch.exp(torch.as_tensor(_x)))((lambda *s: torch.randn(*s, dtype=torch.bfloat16) * 0.2)(P))
        Lambda_im = (lambda *s: torch.randn(*s, dtype=torch.bfloat16) * 0.4)(P) * 1.0
        B_re = (lambda *s: torch.randn(*s, dtype=torch.bfloat16) * 0.2)(P, D) * (D ** -0.5)
        B_im = (lambda *s: torch.randn(*s, dtype=torch.bfloat16) * 0.2)(P, D) * (D ** -0.5)
        C_re = (lambda *s: torch.randn(*s, dtype=torch.bfloat16) * 0.2)(D, P) * (P ** -0.5)
        C_im = (lambda *s: torch.randn(*s, dtype=torch.bfloat16) * 0.2)(D, P) * (P ** -0.5)
        log_dt = (lambda *s: torch.randn(*s, dtype=torch.bfloat16) * 0.2)(P) * 0.3 - 2.0
        Dskip = (lambda *s: torch.randn(*s, dtype=torch.bfloat16) * 0.05)(D)
        return {
            "x": _w((lambda *s: torch.randn(*s, dtype=torch.bfloat16) * 0.05)(B, S, D)),
            "Lambda_re": _w(Lambda_re),
            "Lambda_im": _w(Lambda_im),
            "B_re": _w(B_re),
            "B_im": _w(B_im),
            "C_re": _w(C_re),
            "C_im": _w(C_im),
            "log_dt": _w(log_dt),
            "Dskip": _w(Dskip),
        }
    _A_in = _A_setup()

    def _B_setup():
        B, S, D, H = 1, 2048, 512, 32
        Dh = D // H
        return {
            "x": _w((lambda *s: torch.randn(*s, dtype=torch.bfloat16) * 0.05)(B, S, D)),
            "wq": _w((lambda *s: torch.randn(*s, dtype=torch.bfloat16) * 0.8)(D, H * Dh)),
            "wk": _w((lambda *s: torch.randn(*s, dtype=torch.bfloat16) * 0.8)(D, Dh)),
            "wv": _w((lambda *s: torch.randn(*s, dtype=torch.bfloat16) * 0.05)(D, Dh)),
            "wo": _w((lambda *s: torch.randn(*s, dtype=torch.bfloat16) * 0.05)(H * Dh, D)),
        }
    _B_in = _B_setup()

    return {
        "A_x": _A_in["x"],
        "A_Lambda_re": _A_in["Lambda_re"],
        "A_Lambda_im": _A_in["Lambda_im"],
        "A_B_re": _A_in["B_re"],
        "A_B_im": _A_in["B_im"],
        "A_C_re": _A_in["C_re"],
        "A_C_im": _A_in["C_im"],
        "A_log_dt": _A_in["log_dt"],
        "A_Dskip": _A_in["Dskip"],
        "B_x": _B_in["x"],
        "B_wq": _B_in["wq"],
        "B_wk": _B_in["wk"],
        "B_wv": _B_in["wv"],
        "B_wo": _B_in["wo"],
    }

def reference(A_x, A_Lambda_re, A_Lambda_im, A_B_re, A_B_im, A_C_re, A_C_im, A_log_dt, A_Dskip, B_x, B_wq, B_wk, B_wv, B_wo):
    def _A_ref(x, Lambda_re, Lambda_im, B_re, B_im, C_re, C_im, log_dt, Dskip):
        Bsz, L, H = x.shape
        Lam = Lambda_re + 1j * Lambda_im
        Bmat = B_re + 1j * B_im
        Cmat = C_re + 1j * C_im
        dt = torch.exp(log_dt)
        Lam_bar = torch.exp(dt * Lam)
        B_bar = ((Lam_bar - 1.0) / Lam)[:, None] * Bmat
        Bu = torch.einsum("bld,pd->blp", x + 0j, B_bar)
        h = torch.zeros_like(Bu[:, 0, :])
        hs = []
        for t in range(L):
            h = Lam_bar[None, :] * h + Bu[:, t, :]
            hs.append(h)
        hseq = torch.stack(hs, 1)
        y = 2.0 * torch.einsum("blp,dp->bld", hseq, Cmat).real + x * Dskip[None, None, :]
        return y

    def _B_ref(x, wq, wk, wv, wo):
        B, S, D = x.shape
        H = 32
        Dh = D // H
        q = (lambda x, *d: x.permute(*d))((x @ wq).reshape(B, S, H, Dh), 0, 2, 1, 3)
        k = x @ wk
        v = x @ wv
        scores = torch.einsum("bhqd,bkd->bhqk", q, k) * (Dh ** -0.5)
        p = _softmax(scores, axis=-1)
        o = torch.einsum("bhqk,bkd->bhqd", p, v)
        return (lambda x, *d: x.permute(*d))(o, 0, 2, 1, 3).reshape(B, S, H * Dh) @ wo

    a = _A_ref(A_x, A_Lambda_re, A_Lambda_im, A_B_re, A_B_im, A_C_re, A_C_im, A_log_dt, A_Dskip)
    b = _B_ref(B_x, B_wq, B_wk, B_wv, B_wo)
    return torch.concatenate([a, b], axis=-1)
```

```asm
; @launch grid=(256,1,1) block=(768,1,1) lds=163840
.amdgcn_target "amdgcn-amd-amdhsa--gfx950"
.text
.globl concat_heads__ssm_conv_s5__grouped_kv_mqa__prompt_kernel
.p2align 8
.type concat_heads__ssm_conv_s5__grouped_kv_mqa__prompt_kernel,@function
concat_heads__ssm_conv_s5__grouped_kv_mqa__prompt_kernel:
    s_cmp_ge_u32 s2, 256
    s_cbranch_scc1 L_end
    s_load_dwordx16 s[16:31], s[0:1], 0
    s_load_dwordx16 s[32:47], s[0:1], 64
    s_load_dwordx2 s[48:49], s[0:1], 128
    v_lshrrev_b32 v1, 6, v0
    v_and_b32 v0, 63, v0
    s_and_b32 s4, s2, 7
    v_readfirstlane_b32 s3, v1
    s_lshr_b32 s5, s2, 3
    s_lshr_b32 s72, s5, 3
    s_lshl_b32 s6, s4, 2
    s_add_u32 s6, s6, s72
    s_and_b32 s7, s5, 7
    s_lshr_b32 s8, s4, 1
    s_lshl_b32 s8, s8, 2
    s_add_u32 s8, s8, s72
    s_and_b32 s9, s4, 1
    s_lshl_b32 s9, s9, 3
    s_add_u32 s9, s9, s7
    s_lshr_b32 s73, s5, 1
    s_lshl_b32 s10, s4, 4
    s_add_u32 s10, s10, s73
    s_and_b32 s12, s73, 3
    s_and_b32 s11, s5, 1
    s_lshl_b32 s50, s72, 1
    s_add_u32 s50, s50, s7
    s_and_b32 s50, s50, 7
    s_lshl_b32 s50, s50, 7
    s_add_u32 s74, s3, 0
    s_sub_u32 s75, s3, 0
    s_cmp_lt_u32 s3, 4
    s_cselect_b32 s3, s74, s75
    v_lshrrev_b32 v2, 3, v0
    v_lshrrev_b32 v3, 4, v0
    v_and_b32 v4, 7, v0
    v_xor_b32 v4, v4, v3
    v_lshlrev_b32 v4, 4, v4
    v_lshl_add_u32 v1, v2, 10, v4
    s_waitcnt lgkmcnt(0)
    s_mov_b32 s64, s48
    s_mov_b32 s65, s49
    s_mov_b32 s66, 11534336
    s_mov_b32 s67, 0x20000
    s_cmp_ge_u32 s3, 8
    s_cbranch_scc1 L_S
    s_mov_b32 s52, s34
    s_mov_b32 s53, s35
    s_mov_b32 s54, 2097152
    s_mov_b32 s55, 0x20000
    s_lshl_b32 s74, s6, 16
    s_cmp_lg_u32 s3, 0
    s_cbranch_scc1 L_A
    s_setprio 3
    v_mov_b32 v4, 0
    buffer_load_dwordx2 v[6:7], v4, s[64:67], 0 offen sc1
    s_cmp_eq_u32 s11, 0
    s_cselect_b32 s56, s38, s40
    s_cselect_b32 s57, s39, s41
    s_mov_b32 s58, 16384
    s_mov_b32 s59, 0x20000
    v_lshlrev_b32 v2, 4, v0
    v_xor_b32 v3, 64, v1
    s_lshl_b32 s75, s12, 14
    s_add_u32 s74, s74, s75
    s_lshl_b32 s75, s12, 11
    s_cmp_eq_u32 s11, 0
    v_add_u32 v3, 8192, v3
    s_add_u32 s72, s50, 0
    s_and_b32 s72, s72, 0x380
    s_add_u32 m0, s75, 0
    s_add_u32 s51, s72, s74
    buffer_load_dwordx4 v1, s[52:55], s51 offen lds
    s_add_u32 m0, s75, 1024
    s_lshl_b32 s76, s72, 4
    buffer_load_dwordx4 v3, s[52:55], s51 offen lds
    s_mov_b32 m0, 131072
    s_nop 0
    buffer_load_dwordx4 v2, s[56:59], s76 offen lds
    buffer_load_dwordx4 v2, s[56:59], s76 offen offset:1024 lds
    s_add_u32 s72, s72, 128
    s_and_b32 s72, s72, 0x380
    s_add_u32 m0, s75, 8192
    s_add_u32 s51, s72, s74
    buffer_load_dwordx4 v1, s[52:55], s51 offen lds
    s_add_u32 m0, s75, 9216
    s_lshl_b32 s76, s72, 4
    buffer_load_dwordx4 v3, s[52:55], s51 offen lds
    s_mov_b32 m0, 133120
    s_nop 0
    buffer_load_dwordx4 v2, s[56:59], s76 offen lds
    buffer_load_dwordx4 v2, s[56:59], s76 offen offset:1024 lds
    s_add_u32 s72, s72, 128
    s_and_b32 s72, s72, 0x380
    s_add_u32 m0, s75, 16384
    s_add_u32 s51, s72, s74
    buffer_load_dwordx4 v1, s[52:55], s51 offen lds
    s_add_u32 m0, s75, 17408
    s_lshl_b32 s76, s72, 4
    buffer_load_dwordx4 v3, s[52:55], s51 offen lds
    s_mov_b32 m0, 135168
    s_nop 0
    buffer_load_dwordx4 v2, s[56:59], s76 offen lds
    buffer_load_dwordx4 v2, s[56:59], s76 offen offset:1024 lds
    s_add_u32 s72, s72, 128
    s_and_b32 s72, s72, 0x380
    s_add_u32 m0, s75, 24576
    s_add_u32 s51, s72, s74
    buffer_load_dwordx4 v1, s[52:55], s51 offen lds
    s_add_u32 m0, s75, 25600
    s_lshl_b32 s76, s72, 4
    buffer_load_dwordx4 v3, s[52:55], s51 offen lds
    s_mov_b32 m0, 137216
    s_nop 0
    buffer_load_dwordx4 v2, s[56:59], s76 offen lds
    buffer_load_dwordx4 v2, s[56:59], s76 offen offset:1024 lds
    s_add_u32 s72, s72, 128
    s_and_b32 s72, s72, 0x380
    s_add_u32 m0, s75, 32768
    s_add_u32 s51, s72, s74
    buffer_load_dwordx4 v1, s[52:55], s51 offen lds
    s_add_u32 m0, s75, 33792
    s_lshl_b32 s76, s72, 4
    buffer_load_dwordx4 v3, s[52:55], s51 offen lds
    s_mov_b32 m0, 139264
    s_nop 0
    buffer_load_dwordx4 v2, s[56:59], s76 offen lds
    buffer_load_dwordx4 v2, s[56:59], s76 offen offset:1024 lds
    s_add_u32 s72, s72, 128
    s_and_b32 s72, s72, 0x380
    s_add_u32 m0, s75, 40960
    s_add_u32 s51, s72, s74
    buffer_load_dwordx4 v1, s[52:55], s51 offen lds
    s_add_u32 m0, s75, 41984
    s_lshl_b32 s76, s72, 4
    buffer_load_dwordx4 v3, s[52:55], s51 offen lds
    s_mov_b32 m0, 141312
    s_nop 0
    buffer_load_dwordx4 v2, s[56:59], s76 offen lds
    buffer_load_dwordx4 v2, s[56:59], s76 offen offset:1024 lds
    s_add_u32 s72, s72, 128
    s_and_b32 s72, s72, 0x380
    s_add_u32 m0, s75, 49152
    s_add_u32 s51, s72, s74
    buffer_load_dwordx4 v1, s[52:55], s51 offen lds
    s_add_u32 m0, s75, 50176
    s_lshl_b32 s76, s72, 4
    buffer_load_dwordx4 v3, s[52:55], s51 offen lds
    s_mov_b32 m0, 143360
    s_nop 0
    buffer_load_dwordx4 v2, s[56:59], s76 offen lds
    buffer_load_dwordx4 v2, s[56:59], s76 offen offset:1024 lds
    s_add_u32 s72, s72, 128
    s_and_b32 s72, s72, 0x380
    s_add_u32 m0, s75, 57344
    s_add_u32 s51, s72, s74
    buffer_load_dwordx4 v1, s[52:55], s51 offen lds
    s_add_u32 m0, s75, 58368
    s_lshl_b32 s76, s72, 4
    buffer_load_dwordx4 v3, s[52:55], s51 offen lds
    s_mov_b32 m0, 145408
    s_nop 0
    buffer_load_dwordx4 v2, s[56:59], s76 offen lds
    buffer_load_dwordx4 v2, s[56:59], s76 offen offset:1024 lds
    s_barrier
    v_and_b32 v3, 15, v0
    v_lshrrev_b32 v5, 4, v0
    s_lshl_b32 s77, s12, 4
    v_add_u32 v4, s77, v3
    v_bfe_u32 v160, v4, 1, 3
    v_xor_b32 v160, v160, v5
    v_lshlrev_b32 v160, 4, v160
    v_lshl_add_u32 v4, v4, 7, v160
    v_lshrrev_b32 v160, 2, v3
    v_lshl_add_u32 v160, v5, 3, v160
    v_lshlrev_b32 v160, 5, v160
    v_and_b32 v161, 3, v0
    v_lshl_add_u32 v160, v161, 3, v160
    v_and_b32 v161, 1, v5
    v_lshrrev_b32 v162, 1, v5
    v_xor_b32 v5, 64, v4
    v_lshlrev_b32 v161, 9, v161
    v_lshl_add_u32 v161, v3, 4, v161
    v_lshl_add_u32 v161, v162, 3, v161
    v_add_u32 v3, 131072, v160
    s_lshr_b32 s77, s10, 1
    s_lshl_b32 s77, s77, 10
    s_and_b32 s78, s10, 1
    s_lshl_b32 s78, s78, 8
    s_add_u32 s77, s77, s78
    s_add_u32 s77, s77, 262144
    s_lshl_b32 s78, s11, 16
    s_add_u32 s77, s77, s78
    s_cmp_eq_u32 s11, 0
    s_barrier
    v_mov_b32 v44, 0
    s_mov_b32 exec_lo, 0x00110011
    s_mov_b32 exec_hi, 0x00110011
    v_mov_b32 v44, 0x3f803f80
    s_mov_b64 exec, -1
    v_mov_b32 v40, v44
    v_mov_b32 v41, v44
    v_mov_b32 v42, v44
    v_mov_b32 v43, v44
    v_mov_b32 v45, v44
    v_mov_b32 v46, v44
    v_mov_b32 v47, v44
    v_mov_b32 v48, v44
    v_mov_b32 v49, v44
    v_mov_b32 v50, v44
    v_mov_b32 v51, v44
    v_mov_b32 v52, v44
    v_mov_b32 v53, v44
    v_mov_b32 v54, v44
    v_mov_b32 v55, v44
    v_mov_b32 v56, v44
    v_mov_b32 v57, v44
    v_mov_b32 v58, v44
    v_mov_b32 v59, v44
    v_mov_b32 v60, v44
    v_mov_b32 v61, v44
    v_mov_b32 v62, v44
    v_mov_b32 v63, v44
    v_mov_b32 v64, v44
    v_mov_b32 v65, v44
    v_mov_b32 v66, v44
    v_mov_b32 v67, v44
    v_mov_b32 v68, v44
    v_mov_b32 v69, v44
    v_mov_b32 v70, v44
    v_mov_b32 v71, v44
    v_mov_b32 v72, v44
    v_mov_b32 v73, v44
    v_mov_b32 v74, v44
    v_mov_b32 v75, v44
    v_mov_b32 v76, v44
    v_mov_b32 v77, v44
    v_mov_b32 v78, v44
    v_mov_b32 v79, v44
    v_mov_b32 v80, v44
    v_mov_b32 v81, v44
    v_mov_b32 v82, v44
    v_mov_b32 v83, v44
    v_mov_b32 v84, v44
    v_mov_b32 v85, v44
    v_mov_b32 v86, v44
    v_mov_b32 v87, v44
    v_mov_b32 v88, v44
    v_mov_b32 v89, v44
    v_mov_b32 v90, v44
    v_mov_b32 v91, v44
    v_mov_b32 v92, v44
    v_mov_b32 v93, v44
    v_mov_b32 v94, v44
    v_mov_b32 v95, v44
    v_mov_b32 v96, v44
    v_mov_b32 v97, v44
    v_mov_b32 v98, v44
    v_mov_b32 v99, v44
    v_mov_b32 v100, v44
    v_mov_b32 v101, v44
    v_mov_b32 v102, v44
    v_mov_b32 v103, v44
    v_mov_b32 v167, 1
    v_lshlrev_b32 v166, 4, v0
    v_add_u32 v166, 155648, v166
    v_mov_b32 v163, 153600
    s_waitcnt vmcnt(0)
    v_add_co_u32 v6, vcc, 1, v6
    s_nop 1
    v_addc_co_u32 v7, vcc, 0, v7, vcc
    ds_read_b128 v[104:107], v4 offset:0
    ds_read_b64_tr_b16 v[108:109], v3 offset:0
    ds_read_b64_tr_b16 v[110:111], v3 offset:128
    ds_read_b128 v[112:115], v5 offset:0
    ds_read_b64_tr_b16 v[116:117], v3 offset:1024
    ds_read_b64_tr_b16 v[118:119], v3 offset:1152
    ds_read_b128 v[120:123], v4 offset:8192
    ds_read_b64_tr_b16 v[124:125], v3 offset:2048
    ds_read_b64_tr_b16 v[126:127], v3 offset:2176
    ds_write_b64 v163, v[6:7]
    s_mov_b64 exec, 1
    s_mov_b64 exec, -1
    s_waitcnt lgkmcnt(0)
    s_cbranch_scc0 L_kv_v
    ds_read_b128 v[128:131], v5 offset:8192
    ds_read_b64_tr_b16 v[132:133], v3 offset:3072
    ds_read_b64_tr_b16 v[134:135], v3 offset:3200
    s_waitcnt lgkmcnt(9)
    v_mfma_f32_16x16x32_bf16 v[136:139], v[108:111], v[104:107], 0
    ds_read_b128 v[104:107], v4 offset:16384
    ds_read_b64_tr_b16 v[108:109], v3 offset:4096
    ds_read_b64_tr_b16 v[110:111], v3 offset:4224
    s_waitcnt lgkmcnt(9)
    v_mfma_f32_16x16x32_bf16 v[136:139], v[116:119], v[112:115], v[136:139]
    ds_read_b128 v[112:115], v5 offset:16384
    ds_read_b64_tr_b16 v[116:117], v3 offset:5120
    ds_read_b64_tr_b16 v[118:119], v3 offset:5248
    s_waitcnt lgkmcnt(9)
    v_mfma_f32_16x16x32_bf16 v[136:139], v[124:127], v[120:123], v[136:139]
    ds_read_b128 v[120:123], v4 offset:24576
    ds_read_b64_tr_b16 v[124:125], v3 offset:6144
    ds_read_b64_tr_b16 v[126:127], v3 offset:6272
    s_waitcnt lgkmcnt(9)
    v_mfma_f32_16x16x32_bf16 v[136:139], v[132:135], v[128:131], v[136:139]
    ds_read_b128 v[128:131], v5 offset:24576
    ds_read_b64_tr_b16 v[132:133], v3 offset:7168
    ds_read_b64_tr_b16 v[134:135], v3 offset:7296
    s_waitcnt lgkmcnt(9)
    v_mfma_f32_16x16x32_bf16 v[136:139], v[108:111], v[104:107], v[136:139]
    ds_read_b128 v[104:107], v4 offset:32768
    ds_read_b64_tr_b16 v[108:109], v3 offset:8192
    ds_read_b64_tr_b16 v[110:111], v3 offset:8320
    s_waitcnt lgkmcnt(9)
    v_mfma_f32_16x16x32_bf16 v[136:139], v[116:119], v[112:115], v[136:139]
    ds_read_b128 v[112:115], v5 offset:32768
    ds_read_b64_tr_b16 v[116:117], v3 offset:9216
    ds_read_b64_tr_b16 v[118:119], v3 offset:9344
    s_waitcnt lgkmcnt(9)
    v_mfma_f32_16x16x32_bf16 v[136:139], v[124:127], v[120:123], v[136:139]
    ds_read_b128 v[120:123], v4 offset:40960
    ds_read_b64_tr_b16 v[124:125], v3 offset:10240
    ds_read_b64_tr_b16 v[126:127], v3 offset:10368
    s_waitcnt lgkmcnt(9)
    v_mfma_f32_16x16x32_bf16 v[136:139], v[132:135], v[128:131], v[136:139]
    ds_read_b128 v[128:131], v5 offset:40960
    ds_read_b64_tr_b16 v[132:133], v3 offset:11264
    ds_read_b64_tr_b16 v[134:135], v3 offset:11392
    s_waitcnt lgkmcnt(9)
    v_mfma_f32_16x16x32_bf16 v[136:139], v[108:111], v[104:107], v[136:139]
    ds_read_b128 v[104:107], v4 offset:49152
    ds_read_b64_tr_b16 v[108:109], v3 offset:12288
    ds_read_b64_tr_b16 v[110:111], v3 offset:12416
    s_waitcnt lgkmcnt(9)
    v_mfma_f32_16x16x32_bf16 v[136:139], v[116:119], v[112:115], v[136:139]
    ds_read_b128 v[112:115], v5 offset:49152
    ds_read_b64_tr_b16 v[116:117], v3 offset:13312
    ds_read_b64_tr_b16 v[118:119], v3 offset:13440
    s_waitcnt lgkmcnt(9)
    v_mfma_f32_16x16x32_bf16 v[136:139], v[124:127], v[120:123], v[136:139]
    ds_read_b128 v[120:123], v4 offset:57344
    ds_read_b64_tr_b16 v[124:125], v3 offset:14336
    ds_read_b64_tr_b16 v[126:127], v3 offset:14464
    s_waitcnt lgkmcnt(9)
    v_mfma_f32_16x16x32_bf16 v[136:139], v[132:135], v[128:131], v[136:139]
    ds_read_b128 v[128:131], v5 offset:57344
    ds_read_b64_tr_b16 v[132:133], v3 offset:15360
    ds_read_b64_tr_b16 v[134:135], v3 offset:15488
    s_waitcnt lgkmcnt(9)
    v_mfma_f32_16x16x32_bf16 v[136:139], v[108:111], v[104:107], v[136:139]
    s_waitcnt lgkmcnt(6)
    v_mfma_f32_16x16x32_bf16 v[136:139], v[116:119], v[112:115], v[136:139]
    s_waitcnt lgkmcnt(3)
    v_mfma_f32_16x16x32_bf16 v[136:139], v[124:127], v[120:123], v[136:139]
    s_waitcnt lgkmcnt(0)
    v_mfma_f32_16x16x32_bf16 v[136:139], v[132:135], v[128:131], v[136:139]
    s_branch L_kv_j
L_kv_v:
    ds_read_b128 v[128:131], v5 offset:8192
    ds_read_b64_tr_b16 v[132:133], v3 offset:3072
    ds_read_b64_tr_b16 v[134:135], v3 offset:3200
    s_waitcnt lgkmcnt(9)
    v_mfma_f32_16x16x32_bf16 v[136:139], v[104:107], v[108:111], 0
    ds_read_b128 v[104:107], v4 offset:16384
    ds_read_b64_tr_b16 v[108:109], v3 offset:4096
    ds_read_b64_tr_b16 v[110:111], v3 offset:4224
    s_waitcnt lgkmcnt(9)
    v_mfma_f32_16x16x32_bf16 v[136:139], v[112:115], v[116:119], v[136:139]
    ds_read_b128 v[112:115], v5 offset:16384
    ds_read_b64_tr_b16 v[116:117], v3 offset:5120
    ds_read_b64_tr_b16 v[118:119], v3 offset:5248
    s_waitcnt lgkmcnt(9)
    v_mfma_f32_16x16x32_bf16 v[136:139], v[120:123], v[124:127], v[136:139]
    ds_read_b128 v[120:123], v4 offset:24576
    ds_read_b64_tr_b16 v[124:125], v3 offset:6144
    ds_read_b64_tr_b16 v[126:127], v3 offset:6272
    s_waitcnt lgkmcnt(9)
    v_mfma_f32_16x16x32_bf16 v[136:139], v[128:131], v[132:135], v[136:139]
    ds_read_b128 v[128:131], v5 offset:24576
    ds_read_b64_tr_b16 v[132:133], v3 offset:7168
    ds_read_b64_tr_b16 v[134:135], v3 offset:7296
    s_waitcnt lgkmcnt(9)
    v_mfma_f32_16x16x32_bf16 v[136:139], v[104:107], v[108:111], v[136:139]
    ds_read_b128 v[104:107], v4 offset:32768
    ds_read_b64_tr_b16 v[108:109], v3 offset:8192
    ds_read_b64_tr_b16 v[110:111], v3 offset:8320
    s_waitcnt lgkmcnt(9)
    v_mfma_f32_16x16x32_bf16 v[136:139], v[112:115], v[116:119], v[136:139]
    ds_read_b128 v[112:115], v5 offset:32768
    ds_read_b64_tr_b16 v[116:117], v3 offset:9216
    ds_read_b64_tr_b16 v[118:119], v3 offset:9344
    s_waitcnt lgkmcnt(9)
    v_mfma_f32_16x16x32_bf16 v[136:139], v[120:123], v[124:127], v[136:139]
    ds_read_b128 v[120:123], v4 offset:40960
    ds_read_b64_tr_b16 v[124:125], v3 offset:10240
    ds_read_b64_tr_b16 v[126:127], v3 offset:10368
    s_waitcnt lgkmcnt(9)
    v_mfma_f32_16x16x32_bf16 v[136:139], v[128:131], v[132:135], v[136:139]
    ds_read_b128 v[128:131], v5 offset:40960
    ds_read_b64_tr_b16 v[132:133], v3 offset:11264
    ds_read_b64_tr_b16 v[134:135], v3 offset:11392
    s_waitcnt lgkmcnt(9)
    v_mfma_f32_16x16x32_bf16 v[136:139], v[104:107], v[108:111], v[136:139]
    ds_read_b128 v[104:107], v4 offset:49152
    ds_read_b64_tr_b16 v[108:109], v3 offset:12288
    ds_read_b64_tr_b16 v[110:111], v3 offset:12416
    s_waitcnt lgkmcnt(9)
    v_mfma_f32_16x16x32_bf16 v[136:139], v[112:115], v[116:119], v[136:139]
    ds_read_b128 v[112:115], v5 offset:49152
    ds_read_b64_tr_b16 v[116:117], v3 offset:13312
    ds_read_b64_tr_b16 v[118:119], v3 offset:13440
    s_waitcnt lgkmcnt(9)
    v_mfma_f32_16x16x32_bf16 v[136:139], v[120:123], v[124:127], v[136:139]
    ds_read_b128 v[120:123], v4 offset:57344
    ds_read_b64_tr_b16 v[124:125], v3 offset:14336
    ds_read_b64_tr_b16 v[126:127], v3 offset:14464
    s_waitcnt lgkmcnt(9)
    v_mfma_f32_16x16x32_bf16 v[136:139], v[128:131], v[132:135], v[136:139]
    ds_read_b128 v[128:131], v5 offset:57344
    ds_read_b64_tr_b16 v[132:133], v3 offset:15360
    ds_read_b64_tr_b16 v[134:135], v3 offset:15488
    s_waitcnt lgkmcnt(9)
    v_mfma_f32_16x16x32_bf16 v[136:139], v[104:107], v[108:111], v[136:139]
    s_waitcnt lgkmcnt(6)
    v_mfma_f32_16x16x32_bf16 v[136:139], v[112:115], v[116:119], v[136:139]
    s_waitcnt lgkmcnt(3)
    v_mfma_f32_16x16x32_bf16 v[136:139], v[120:123], v[124:127], v[136:139]
    s_waitcnt lgkmcnt(0)
    v_mfma_f32_16x16x32_bf16 v[136:139], v[128:131], v[132:135], v[136:139]
L_kv_j:
    s_mov_b64 exec, 1
    ds_add_u32 v163, v167 offset:96
    s_mov_b64 exec, -1
    s_lshl_b32 s78, s10, 1
    s_add_u32 s78, s78, s11
    s_lshl_b32 s78, s78, 7
    s_add_u32 s78, s78, 393216
    v_mov_b32 v5, 0
    s_cmp_eq_u32 s11, 0
    s_cselect_b32 s76, 0x3eb8aa3b, 1.0
    v_mul_f32 v136, s76, v136
    v_mul_f32 v137, s76, v137
    v_mul_f32 v138, s76, v138
    v_mul_f32 v139, s76, v139
    v_cvt_pk_bf16_f32 v152, v136, v137
    v_cvt_pk_bf16_f32 v153, v138, v139
    buffer_store_dwordx2 v[152:153], v161, s[64:67], s77 offen sc1
    s_waitcnt vmcnt(0)
    s_mov_b64 exec, 1
    buffer_store_dwordx2 v[6:7], v5, s[64:67], s78 offen sc1
    s_mov_b64 exec, -1
    v_mov_b32 v7, 153600
    s_branch L_A_lo
L_A:
    s_sub_u32 s75, s3, 1
    s_lshl_b32 s76, s12, 1
    s_cmp_ge_u32 s75, s76
    s_cselect_b32 s76, 2, 0
    s_add_u32 s75, s75, s76
    s_and_b32 s76, s75, 1
    s_lshl_b32 s76, s76, 6
    v_xor_b32 v1, s76, v1
    s_lshl_b32 s76, s75, 13
    s_add_u32 s74, s74, s76
    s_lshl_b32 s75, s75, 10
    v_mov_b32 v7, 153600
    s_cmp_lg_u32 s3, 7
    s_cbranch_scc1 L_A_ld
    v_lshl_add_u32 v2, v0, 2, v7
    v_mov_b32 v3, 0
    ds_write_b32 v2, v3
    s_waitcnt lgkmcnt(0)
    s_barrier
    s_branch L_A_init
L_A_ld:
    s_barrier
L_A_init:
    v_mov_b32 v44, 0
    s_mov_b32 exec_lo, 0x00110011
    s_mov_b32 exec_hi, 0x00110011
    v_mov_b32 v44, 0x3f803f80
    s_mov_b64 exec, -1
    v_mov_b32 v40, v44
    v_mov_b32 v41, v44
    v_mov_b32 v42, v44
    v_mov_b32 v43, v44
    v_mov_b32 v45, v44
    v_mov_b32 v46, v44
    v_mov_b32 v47, v44
    v_mov_b32 v48, v44
    v_mov_b32 v49, v44
    v_mov_b32 v50, v44
    v_mov_b32 v51, v44
    v_mov_b32 v52, v44
    v_mov_b32 v53, v44
    v_mov_b32 v54, v44
    v_mov_b32 v55, v44
    v_mov_b32 v56, v44
    v_mov_b32 v57, v44
    v_mov_b32 v58, v44
    v_mov_b32 v59, v44
    v_mov_b32 v60, v44
    v_mov_b32 v61, v44
    v_mov_b32 v62, v44
    v_mov_b32 v63, v44
    v_mov_b32 v64, v44
    v_mov_b32 v65, v44
    v_mov_b32 v66, v44
    v_mov_b32 v67, v44
    v_mov_b32 v68, v44
    v_mov_b32 v69, v44
    v_mov_b32 v70, v44
    v_mov_b32 v71, v44
    v_mov_b32 v72, v44
    v_mov_b32 v73, v44
    v_mov_b32 v74, v44
    v_mov_b32 v75, v44
    v_mov_b32 v76, v44
    v_mov_b32 v77, v44
    v_mov_b32 v78, v44
    v_mov_b32 v79, v44
    v_mov_b32 v80, v44
    v_mov_b32 v81, v44
    v_mov_b32 v82, v44
    v_mov_b32 v83, v44
    v_mov_b32 v84, v44
    v_mov_b32 v85, v44
    v_mov_b32 v86, v44
    v_mov_b32 v87, v44
    v_mov_b32 v88, v44
    v_mov_b32 v89, v44
    v_mov_b32 v90, v44
    v_mov_b32 v91, v44
    v_mov_b32 v92, v44
    v_mov_b32 v93, v44
    v_mov_b32 v94, v44
    v_mov_b32 v95, v44
    v_mov_b32 v96, v44
    v_mov_b32 v97, v44
    v_mov_b32 v98, v44
    v_mov_b32 v99, v44
    v_mov_b32 v100, v44
    v_mov_b32 v101, v44
    v_mov_b32 v102, v44
    v_mov_b32 v103, v44
    v_mov_b32 v167, 1
    v_lshlrev_b32 v166, 4, v0
    v_add_u32 v166, 155648, v166
    s_barrier
    s_cmp_eq_u32 s3, 7
    s_cbranch_scc1 L_A_q
    s_mov_b32 s72, s50
    s_add_u32 s51, s72, s74
    s_add_u32 m0, s75, 0
    s_add_u32 s79, s51, 0
    buffer_load_dwordx4 v1, s[52:55], s79 offen  lds
    s_add_u32 s72, s72, 128
    s_and_b32 s72, s72, 0x380
    s_add_u32 s51, s72, s74
    s_add_u32 m0, s75, 8192
    s_add_u32 s79, s51, 0
    buffer_load_dwordx4 v1, s[52:55], s79 offen  lds
    s_add_u32 s72, s72, 128
    s_and_b32 s72, s72, 0x380
    s_add_u32 s51, s72, s74
    s_add_u32 m0, s75, 16384
    s_add_u32 s79, s51, 0
    buffer_load_dwordx4 v1, s[52:55], s79 offen  lds
    s_add_u32 s72, s72, 128
    s_and_b32 s72, s72, 0x380
    s_add_u32 s51, s72, s74
    s_add_u32 m0, s75, 24576
    s_add_u32 s79, s51, 0
    buffer_load_dwordx4 v1, s[52:55], s79 offen  lds
    s_add_u32 s72, s72, 128
    s_and_b32 s72, s72, 0x380
    s_add_u32 s51, s72, s74
    s_add_u32 m0, s75, 32768
    s_add_u32 s79, s51, 0
    buffer_load_dwordx4 v1, s[52:55], s79 offen  lds
    s_add_u32 s72, s72, 128
    s_and_b32 s72, s72, 0x380
    s_add_u32 s51, s72, s74
    s_add_u32 m0, s75, 40960
    s_add_u32 s79, s51, 0
    buffer_load_dwordx4 v1, s[52:55], s79 offen  lds
    s_add_u32 s72, s72, 128
    s_and_b32 s72, s72, 0x380
    s_add_u32 s51, s72, s74
    s_add_u32 m0, s75, 49152
    s_add_u32 s79, s51, 0
    buffer_load_dwordx4 v1, s[52:55], s79 offen  lds
    s_add_u32 s72, s72, 128
    s_and_b32 s72, s72, 0x380
    s_add_u32 s51, s72, s74
    s_add_u32 m0, s75, 57344
    s_add_u32 s79, s51, 0
    buffer_load_dwordx4 v1, s[52:55], s79 offen  lds
    s_cmp_lt_u32 s3, 4
    s_cbranch_scc1 L_A_hi
L_A_q:
    v_and_b32 v2, 31, v0
    s_bfe_u32 s75, s3, 0x10001
    s_lshl_b32 s76, s75, 5
    v_add_u32 v2, s76, v2
    v_lshrrev_b32 v3, 5, v0
    v_bfe_u32 v4, v2, 1, 3
    v_xor_b32 v4, v4, v3
    v_lshlrev_b32 v4, 4, v4
    v_lshl_add_u32 v152, v2, 7, v4
    v_xor_b32 v153, 32, v152
    v_xor_b32 v154, 64, v152
    v_xor_b32 v155, 0x60, v152
    v_bfe_u32 v2, v0, 2, 2
    v_lshl_add_u32 v4, v3, 3, v2
    v_lshlrev_b32 v4, 7, v4
    v_bfe_u32 v5, v0, 4, 1
    v_bfe_u32 v6, v0, 1, 1
    v_lshl_add_u32 v5, v5, 1, v6
    s_and_b32 s76, s3, 1
    v_lshrrev_b32 v2, 1, v2
    v_xor_b32 v2, s76, v2
    v_lshl_add_u32 v5, v2, 2, v5
    v_lshl_add_u32 v4, v5, 4, v4
    v_and_b32 v6, 1, v0
    v_lshl_add_u32 v4, v6, 3, v4
    v_add_u32 v156, 65536, v4
    s_lshl_b32 s75, s75, 12
    s_lshl_b32 s76, s76, 11
    s_add_u32 s75, s75, s76
    v_add_u32 v157, s75, v166
    s_lshl_b32 s74, s3, 12
    s_add_u32 s74, s74, 393216
    s_lshl_b32 s75, s3, 13
    s_add_u32 s76, s75, 327680
    s_add_u32 s75, s75, 262144
    s_lshl_b32 s72, s7, 10
    s_add_u32 s16, s75, s72
    s_add_u32 s24, s76, s72
    s_add_u32 s72, s72, 1024
    s_and_b32 s72, s72, 0x1c00
    s_add_u32 s17, s75, s72
    s_add_u32 s25, s76, s72
    s_add_u32 s72, s72, 1024
    s_and_b32 s72, s72, 0x1c00
    s_add_u32 s18, s75, s72
    s_add_u32 s26, s76, s72
    s_add_u32 s72, s72, 1024
    s_and_b32 s72, s72, 0x1c00
    s_add_u32 s19, s75, s72
    s_add_u32 s27, s76, s72
    s_add_u32 s72, s72, 1024
    s_and_b32 s72, s72, 0x1c00
    s_add_u32 s20, s75, s72
    s_add_u32 s28, s76, s72
    s_add_u32 s72, s72, 1024
    s_and_b32 s72, s72, 0x1c00
    s_add_u32 s21, s75, s72
    s_add_u32 s29, s76, s72
    s_add_u32 s72, s72, 1024
    s_and_b32 s72, s72, 0x1c00
    s_add_u32 s22, s75, s72
    s_add_u32 s30, s76, s72
    s_add_u32 s72, s72, 1024
    s_and_b32 s72, s72, 0x1c00
    s_add_u32 s23, s75, s72
    s_add_u32 s31, s76, s72
    s_add_u32 s72, s3, 1
    s_and_b32 s72, s72, 3
    s_and_b32 s73, s3, 4
    s_or_b32 s72, s72, s73
    s_lshl_b32 s72, s72, 2
    s_add_u32 s32, s72, 153632
    s_mov_b32 s33, 153616
    s_add_u32 s34, s73, 153624
    s_lshl_b32 s35, s73, 13
    s_and_b32 s73, s3, 3
    s_lshl_b32 s73, s73, 10
    s_add_u32 s35, s35, s73
    s_lshl_b32 s73, s7, 12
    s_add_u32 s35, s35, s73
    s_lshl_b32 s73, s6, 16
    s_add_u32 s35, s35, s73
    s_add_u32 s35, s35, 1048576
    s_cmp_lt_u32 s3, 4
    s_cselect_b32 s37, 5, 7
    s_mov_b32 s76, 0x83a1c7e5
    s_bitcmp1_b32 s3, 0
    s_cselect_b32 s76, 0x90b2d4f6, s76
    s_bitcmp1_b32 s3, 1
    s_cselect_b32 s72, 0x22222222, 0
    s_xor_b32 s76, s76, s72
    s_bitcmp1_b32 s3, 2
    s_cselect_b32 s72, 0x44444444, 0
    s_xor_b32 s76, s76, s72
    s_lshl_b32 s77, s76, 11
    s_and_b32 s77, s77, 0x7800
    s_lshr_b32 s78, s77, 3
    s_waitcnt vmcnt(0)
    s_mov_b64 exec, 1
    ds_add_u32 v7, v167 offset:96
    s_mov_b64 exec, -1
    s_mov_b32 s80, 262144
L_lw_1:
    ds_read_b32 v6, v7 offset:96
    s_waitcnt lgkmcnt(0)
    v_readfirstlane_b32 s72, v6
    s_nop 0
    s_cmp_ge_u32 s72, 12
    s_cbranch_scc1 L_lw_ok_2
    s_sub_u32 s80, s80, 1
    s_cmp_lg_u32 s80, 0
    s_cbranch_scc1 L_lw_1
L_lw_ok_2:
    ds_read_b128 v[8:11], v152 offset:0
    ds_read_b64_tr_b16 v[12:13], v156 offset:0
    ds_read_b64_tr_b16 v[14:15], v156 offset:512
    ds_read_b128 v[16:19], v153 offset:0
    ds_read_b64_tr_b16 v[20:21], v156 offset:2048
    ds_read_b64_tr_b16 v[22:23], v156 offset:2560
    ds_read_b128 v[24:27], v154 offset:0
    ds_read_b64_tr_b16 v[28:29], v156 offset:4096
    ds_read_b64_tr_b16 v[30:31], v156 offset:4608
    ds_read_b128 v[32:35], v155 offset:0
    ds_read_b64_tr_b16 v[36:37], v156 offset:6144
    ds_read_b64_tr_b16 v[38:39], v156 offset:6656
    ds_read_b128 v[104:107], v152 offset:8192
    ds_read_b64_tr_b16 v[108:109], v156 offset:8192
    ds_read_b64_tr_b16 v[110:111], v156 offset:8704
    s_waitcnt lgkmcnt(12)
    v_mfma_f32_32x32x16_bf16 v[136:151], v[12:15], v[8:11], 0
    ds_read_b128 v[112:115], v153 offset:8192
    ds_read_b64_tr_b16 v[116:117], v156 offset:10240
    ds_read_b64_tr_b16 v[118:119], v156 offset:10752
    s_waitcnt lgkmcnt(12)
    v_mfma_f32_32x32x16_bf16 v[136:151], v[20:23], v[16:19], v[136:151]
    ds_read_b128 v[8:11], v154 offset:8192
    ds_read_b64_tr_b16 v[12:13], v156 offset:12288
    ds_read_b64_tr_b16 v[14:15], v156 offset:12800
    s_waitcnt lgkmcnt(12)
    v_mfma_f32_32x32x16_bf16 v[136:151], v[28:31], v[24:27], v[136:151]
    ds_read_b128 v[16:19], v155 offset:8192
    ds_read_b64_tr_b16 v[20:21], v156 offset:14336
    ds_read_b64_tr_b16 v[22:23], v156 offset:14848
    s_waitcnt lgkmcnt(12)
    v_mfma_f32_32x32x16_bf16 v[136:151], v[36:39], v[32:35], v[136:151]
    ds_read_b128 v[24:27], v152 offset:16384
    ds_read_b64_tr_b16 v[28:29], v156 offset:16384
    ds_read_b64_tr_b16 v[30:31], v156 offset:16896
    s_waitcnt lgkmcnt(12)
    v_mfma_f32_32x32x16_bf16 v[136:151], v[108:111], v[104:107], v[136:151]
    ds_read_b128 v[32:35], v153 offset:16384
    ds_read_b64_tr_b16 v[36:37], v156 offset:18432
    ds_read_b64_tr_b16 v[38:39], v156 offset:18944
    s_waitcnt lgkmcnt(12)
    v_mfma_f32_32x32x16_bf16 v[136:151], v[116:119], v[112:115], v[136:151]
    ds_read_b128 v[104:107], v154 offset:16384
    ds_read_b64_tr_b16 v[108:109], v156 offset:20480
    ds_read_b64_tr_b16 v[110:111], v156 offset:20992
    s_waitcnt lgkmcnt(12)
    v_mfma_f32_32x32x16_bf16 v[136:151], v[12:15], v[8:11], v[136:151]
    ds_read_b128 v[112:115], v155 offset:16384
    ds_read_b64_tr_b16 v[116:117], v156 offset:22528
    ds_read_b64_tr_b16 v[118:119], v156 offset:23040
    s_waitcnt lgkmcnt(12)
    v_mfma_f32_32x32x16_bf16 v[136:151], v[20:23], v[16:19], v[136:151]
    ds_read_b128 v[8:11], v152 offset:24576
    ds_read_b64_tr_b16 v[12:13], v156 offset:24576
    ds_read_b64_tr_b16 v[14:15], v156 offset:25088
    s_waitcnt lgkmcnt(12)
    v_mfma_f32_32x32x16_bf16 v[136:151], v[28:31], v[24:27], v[136:151]
    ds_read_b128 v[16:19], v153 offset:24576
    ds_read_b64_tr_b16 v[20:21], v156 offset:26624
    ds_read_b64_tr_b16 v[22:23], v156 offset:27136
    s_waitcnt lgkmcnt(12)
    v_mfma_f32_32x32x16_bf16 v[136:151], v[36:39], v[32:35], v[136:151]
    ds_read_b128 v[24:27], v154 offset:24576
    ds_read_b64_tr_b16 v[28:29], v156 offset:28672
    ds_read_b64_tr_b16 v[30:31], v156 offset:29184
    s_waitcnt lgkmcnt(12)
    v_mfma_f32_32x32x16_bf16 v[136:151], v[108:111], v[104:107], v[136:151]
    ds_read_b128 v[32:35], v155 offset:24576
    ds_read_b64_tr_b16 v[36:37], v156 offset:30720
    ds_read_b64_tr_b16 v[38:39], v156 offset:31232
    s_waitcnt lgkmcnt(12)
    v_mfma_f32_32x32x16_bf16 v[136:151], v[116:119], v[112:115], v[136:151]
    ds_read_b128 v[104:107], v152 offset:32768
    ds_read_b64_tr_b16 v[108:109], v156 offset:32768
    ds_read_b64_tr_b16 v[110:111], v156 offset:33280
    s_waitcnt lgkmcnt(12)
    v_mfma_f32_32x32x16_bf16 v[136:151], v[12:15], v[8:11], v[136:151]
    ds_read_b128 v[112:115], v153 offset:32768
    ds_read_b64_tr_b16 v[116:117], v156 offset:34816
    ds_read_b64_tr_b16 v[118:119], v156 offset:35328
    s_waitcnt lgkmcnt(12)
    v_mfma_f32_32x32x16_bf16 v[136:151], v[20:23], v[16:19], v[136:151]
    ds_read_b128 v[8:11], v154 offset:32768
    ds_read_b64_tr_b16 v[12:13], v156 offset:36864
    ds_read_b64_tr_b16 v[14:15], v156 offset:37376
    s_waitcnt lgkmcnt(12)
    v_mfma_f32_32x32x16_bf16 v[136:151], v[28:31], v[24:27], v[136:151]
    ds_read_b128 v[16:19], v155 offset:32768
    ds_read_b64_tr_b16 v[20:21], v156 offset:38912
    ds_read_b64_tr_b16 v[22:23], v156 offset:39424
    s_waitcnt lgkmcnt(12)
    v_mfma_f32_32x32x16_bf16 v[136:151], v[36:39], v[32:35], v[136:151]
    ds_read_b128 v[24:27], v152 offset:40960
    ds_read_b64_tr_b16 v[28:29], v156 offset:40960
    ds_read_b64_tr_b16 v[30:31], v156 offset:41472
    s_waitcnt lgkmcnt(12)
    v_mfma_f32_32x32x16_bf16 v[136:151], v[108:111], v[104:107], v[136:151]
    ds_read_b128 v[32:35], v153 offset:40960
    ds_read_b64_tr_b16 v[36:37], v156 offset:43008
    ds_read_b64_tr_b16 v[38:39], v156 offset:43520
    s_waitcnt lgkmcnt(12)
    v_mfma_f32_32x32x16_bf16 v[136:151], v[116:119], v[112:115], v[136:151]
    ds_read_b128 v[104:107], v154 offset:40960
    ds_read_b64_tr_b16 v[108:109], v156 offset:45056
    ds_read_b64_tr_b16 v[110:111], v156 offset:45568
    s_waitcnt lgkmcnt(12)
    v_mfma_f32_32x32x16_bf16 v[136:151], v[12:15], v[8:11], v[136:151]
    ds_read_b128 v[112:115], v155 offset:40960
    ds_read_b64_tr_b16 v[116:117], v156 offset:47104
    ds_read_b64_tr_b16 v[118:119], v156 offset:47616
    s_waitcnt lgkmcnt(12)
    v_mfma_f32_32x32x16_bf16 v[136:151], v[20:23], v[16:19], v[136:151]
    ds_read_b128 v[8:11], v152 offset:49152
    ds_read_b64_tr_b16 v[12:13], v156 offset:49152
    ds_read_b64_tr_b16 v[14:15], v156 offset:49664
    s_waitcnt lgkmcnt(12)
    v_mfma_f32_32x32x16_bf16 v[136:151], v[28:31], v[24:27], v[136:151]
    ds_read_b128 v[16:19], v153 offset:49152
    ds_read_b64_tr_b16 v[20:21], v156 offset:51200
    ds_read_b64_tr_b16 v[22:23], v156 offset:51712
    s_waitcnt lgkmcnt(12)
    v_mfma_f32_32x32x16_bf16 v[136:151], v[36:39], v[32:35], v[136:151]
    ds_read_b128 v[24:27], v154 offset:49152
    ds_read_b64_tr_b16 v[28:29], v156 offset:53248
    ds_read_b64_tr_b16 v[30:31], v156 offset:53760
    s_waitcnt lgkmcnt(12)
    v_mfma_f32_32x32x16_bf16 v[136:151], v[108:111], v[104:107], v[136:151]
    ds_read_b128 v[32:35], v155 offset:49152
    ds_read_b64_tr_b16 v[36:37], v156 offset:55296
    ds_read_b64_tr_b16 v[38:39], v156 offset:55808
    s_waitcnt lgkmcnt(12)
    v_mfma_f32_32x32x16_bf16 v[136:151], v[116:119], v[112:115], v[136:151]
    ds_read_b128 v[104:107], v152 offset:57344
    ds_read_b64_tr_b16 v[108:109], v156 offset:57344
    ds_read_b64_tr_b16 v[110:111], v156 offset:57856
    s_waitcnt lgkmcnt(12)
    v_mfma_f32_32x32x16_bf16 v[136:151], v[12:15], v[8:11], v[136:151]
    ds_read_b128 v[112:115], v153 offset:57344
    ds_read_b64_tr_b16 v[116:117], v156 offset:59392
    ds_read_b64_tr_b16 v[118:119], v156 offset:59904
    s_waitcnt lgkmcnt(12)
    v_mfma_f32_32x32x16_bf16 v[136:151], v[20:23], v[16:19], v[136:151]
    ds_read_b128 v[8:11], v154 offset:57344
    ds_read_b64_tr_b16 v[12:13], v156 offset:61440
    ds_read_b64_tr_b16 v[14:15], v156 offset:61952
    s_waitcnt lgkmcnt(12)
    v_mfma_f32_32x32x16_bf16 v[136:151], v[28:31], v[24:27], v[136:151]
    ds_read_b128 v[16:19], v155 offset:57344
    ds_read_b64_tr_b16 v[20:21], v156 offset:63488
    ds_read_b64_tr_b16 v[22:23], v156 offset:64000
    s_waitcnt lgkmcnt(12)
    v_mfma_f32_32x32x16_bf16 v[136:151], v[36:39], v[32:35], v[136:151]
    s_waitcnt lgkmcnt(9)
    v_mfma_f32_32x32x16_bf16 v[136:151], v[108:111], v[104:107], v[136:151]
    s_waitcnt lgkmcnt(6)
    v_mfma_f32_32x32x16_bf16 v[136:151], v[116:119], v[112:115], v[136:151]
    s_waitcnt lgkmcnt(3)
    v_mfma_f32_32x32x16_bf16 v[136:151], v[12:15], v[8:11], v[136:151]
    s_waitcnt lgkmcnt(0)
    v_mfma_f32_32x32x16_bf16 v[136:151], v[20:23], v[16:19], v[136:151]
    s_nop 11
    v_cvt_pk_bf16_f32 v104, v136, v137
    v_cvt_pk_bf16_f32 v105, v138, v139
    v_cvt_pk_bf16_f32 v106, v140, v141
    v_cvt_pk_bf16_f32 v107, v142, v143
    ds_write_b128 v157, v[104:107] offset:0
    v_cvt_pk_bf16_f32 v108, v144, v145
    v_cvt_pk_bf16_f32 v109, v146, v147
    v_cvt_pk_bf16_f32 v110, v148, v149
    v_cvt_pk_bf16_f32 v111, v150, v151
    ds_write_b128 v157, v[108:111] offset:1024
    s_mov_b64 exec, 1
    ds_add_u32 v7, v167 offset:64
    s_mov_b64 exec, -1
    s_branch L_A_b2
L_A_hi:
    s_waitcnt vmcnt(0)
    s_mov_b64 exec, 1
    ds_add_u32 v7, v167 offset:96
    s_mov_b64 exec, -1
L_A_lo:
    s_lshl_b32 s74, s3, 12
    s_add_u32 s74, s74, 393216
    s_lshl_b32 s75, s3, 13
    s_add_u32 s76, s75, 327680
    s_add_u32 s75, s75, 262144
    s_lshl_b32 s72, s7, 10
    s_add_u32 s16, s75, s72
    s_add_u32 s24, s76, s72
    s_add_u32 s72, s72, 1024
    s_and_b32 s72, s72, 0x1c00
    s_add_u32 s17, s75, s72
    s_add_u32 s25, s76, s72
    s_add_u32 s72, s72, 1024
    s_and_b32 s72, s72, 0x1c00
    s_add_u32 s18, s75, s72
    s_add_u32 s26, s76, s72
    s_add_u32 s72, s72, 1024
    s_and_b32 s72, s72, 0x1c00
    s_add_u32 s19, s75, s72
    s_add_u32 s27, s76, s72
    s_add_u32 s72, s72, 1024
    s_and_b32 s72, s72, 0x1c00
    s_add_u32 s20, s75, s72
    s_add_u32 s28, s76, s72
    s_add_u32 s72, s72, 1024
    s_and_b32 s72, s72, 0x1c00
    s_add_u32 s21, s75, s72
    s_add_u32 s29, s76, s72
    s_add_u32 s72, s72, 1024
    s_and_b32 s72, s72, 0x1c00
    s_add_u32 s22, s75, s72
    s_add_u32 s30, s76, s72
    s_add_u32 s72, s72, 1024
    s_and_b32 s72, s72, 0x1c00
    s_add_u32 s23, s75, s72
    s_add_u32 s31, s76, s72
    s_add_u32 s72, s3, 1
    s_and_b32 s72, s72, 3
    s_and_b32 s73, s3, 4
    s_or_b32 s72, s72, s73
    s_lshl_b32 s72, s72, 2
    s_add_u32 s32, s72, 153632
    s_mov_b32 s33, 153616
    s_add_u32 s34, s73, 153624
    s_lshl_b32 s35, s73, 13
    s_and_b32 s73, s3, 3
    s_lshl_b32 s73, s73, 10
    s_add_u32 s35, s35, s73
    s_lshl_b32 s73, s7, 12
    s_add_u32 s35, s35, s73
    s_lshl_b32 s73, s6, 16
    s_add_u32 s35, s35, s73
    s_add_u32 s35, s35, 1048576
    s_cmp_lt_u32 s3, 4
    s_cselect_b32 s37, 5, 7
    s_mov_b32 s76, 0x83a1c7e5
    s_bitcmp1_b32 s3, 0
    s_cselect_b32 s76, 0x90b2d4f6, s76
    s_bitcmp1_b32 s3, 1
    s_cselect_b32 s72, 0x22222222, 0
    s_xor_b32 s76, s76, s72
    s_bitcmp1_b32 s3, 2
    s_cselect_b32 s72, 0x44444444, 0
    s_xor_b32 s76, s76, s72
    s_lshl_b32 s77, s76, 11
    s_and_b32 s77, s77, 0x7800
    s_lshr_b32 s78, s77, 3
    s_mov_b32 s80, 262144
L_lw_3:
    ds_read_b32 v6, v7 offset:96
    s_waitcnt lgkmcnt(0)
    v_readfirstlane_b32 s72, v6
    s_nop 0
    s_cmp_ge_u32 s72, 12
    s_cbranch_scc1 L_lw_ok_4
    s_sleep 1
    s_sub_u32 s80, s80, 1
    s_cmp_lg_u32 s80, 0
    s_cbranch_scc1 L_lw_3
L_lw_ok_4:
L_A_b2:
    v_mov_b32 v2, 153600
    ds_read_b64 v[6:7], v2
    v_and_b32 v2, 31, v0
    v_lshrrev_b32 v3, 5, v0
    v_lshl_add_u32 v2, v3, 31, v2
    v_lshlrev_b32 v2, 7, v2
    v_lshlrev_b32 v1, 4, v0
    s_lshr_b32 s72, s77, 1
    s_add_u32 s72, s72, 114688
    v_lshl_add_u32 v166, v0, 4, s72
    s_mov_b32 s81, 0
    s_mov_b32 s82, 0x07060302
    s_mov_b32 s84, 6
    s_waitcnt lgkmcnt(0)
    s_setprio 3
    s_mov_b32 s80, 16384
L_kv_5:
    buffer_load_dwordx2 v[104:105], v2, s[64:67], s74 offen sc1
    s_waitcnt vmcnt(0)
    v_cmp_eq_u64 vcc, v[104:105], v[6:7]
    s_nop 0
    s_cmp_eq_u64 vcc, -1
    s_cbranch_scc1 L_kv_ok_6
    s_sleep 2
    s_sub_u32 s80, s80, 1
    s_cmp_lg_u32 s80, 0
    s_cbranch_scc1 L_kv_5
L_kv_ok_6:
L_nopoll:
    v_mov_b32 v4, 153600
    s_cmp_lt_u32 s3, 4
    s_cbranch_scc1 L_ldall
    s_mov_b32 s80, 262144
L_lw_7:
    ds_read_b32 v104, v4 offset:20
    s_waitcnt lgkmcnt(0)
    v_readfirstlane_b32 s72, v104
    s_nop 0
    s_cmp_ge_u32 s72, 4
    s_cbranch_scc1 L_lw_ok_8
    s_sleep 1
    s_sub_u32 s80, s80, 1
    s_cmp_lg_u32 s80, 0
    s_cbranch_scc1 L_lw_7
L_lw_ok_8:
L_ldall:
    s_mov_b32 s72, 0xffff
    s_mov_b32 s73, 0xffff
    buffer_load_dwordx4 v[8:11], v1, s[64:67], s16 offen sc1
    buffer_load_dwordx4 v[12:15], v1, s[64:67], s17 offen sc1
    s_mov_b64 exec, s[72:73]
    buffer_load_dwordx4 v[40:43], v1, s[64:67], s24 offen offset:0 sc1
    s_mov_b64 exec, -1
    buffer_load_dwordx4 v[16:19], v1, s[64:67], s18 offen sc1
    s_mov_b64 exec, s[72:73]
    buffer_load_dwordx4 v[44:47], v1, s[64:67], s24 offen offset:256 sc1
    buffer_load_dwordx4 v[48:51], v1, s[64:67], s25 offen offset:0 sc1
    s_mov_b64 exec, -1
    buffer_load_dwordx4 v[20:23], v1, s[64:67], s19 offen sc1
    s_mov_b64 exec, s[72:73]
    buffer_load_dwordx4 v[52:55], v1, s[64:67], s25 offen offset:256 sc1
    buffer_load_dwordx4 v[56:59], v1, s[64:67], s26 offen offset:0 sc1
    s_mov_b64 exec, -1
    buffer_load_dwordx4 v[24:27], v1, s[64:67], s20 offen sc1
    s_mov_b64 exec, s[72:73]
    buffer_load_dwordx4 v[60:63], v1, s[64:67], s26 offen offset:256 sc1
    buffer_load_dwordx4 v[64:67], v1, s[64:67], s27 offen offset:0 sc1
    s_mov_b64 exec, -1
    buffer_load_dwordx4 v[28:31], v1, s[64:67], s21 offen sc1
    s_mov_b64 exec, s[72:73]
    buffer_load_dwordx4 v[68:71], v1, s[64:67], s27 offen offset:256 sc1
    buffer_load_dwordx4 v[72:75], v1, s[64:67], s28 offen offset:0 sc1
    s_mov_b64 exec, -1
    buffer_load_dwordx4 v[32:35], v1, s[64:67], s22 offen sc1
    s_mov_b64 exec, s[72:73]
    buffer_load_dwordx4 v[76:79], v1, s[64:67], s28 offen offset:256 sc1
    buffer_load_dwordx4 v[80:83], v1, s[64:67], s29 offen offset:0 sc1
    s_mov_b64 exec, -1
    buffer_load_dwordx4 v[36:39], v1, s[64:67], s23 offen sc1
    s_mov_b64 exec, s[72:73]
    buffer_load_dwordx4 v[84:87], v1, s[64:67], s29 offen offset:256 sc1
    buffer_load_dwordx4 v[88:91], v1, s[64:67], s30 offen offset:0 sc1
    buffer_load_dwordx4 v[92:95], v1, s[64:67], s30 offen offset:256 sc1
    buffer_load_dwordx4 v[96:99], v1, s[64:67], s31 offen offset:0 sc1
    buffer_load_dwordx4 v[100:103], v1, s[64:67], s31 offen offset:256 sc1
L_ldd:
    s_mov_b64 exec, 1
    ds_add_u32 v4, v167 offset:20
    s_mov_b64 exec, -1
    s_lshl_b32 s72, s3, 2
    s_add_u32 s72, s72, 153632
    v_lshlrev_b32 v2, 2, v0
    v_add_u32 v2, 153856, v2
    v_writelane_b32 v2, s72, 0
    s_xor_b32 s72, s72, 8
    v_and_b32 v3, 1, v0
    v_lshlrev_b32 v3, 4, v3
    v_xor_b32 v3, s72, v3
    v_add_u32 v5, 114688, v1
    v_lshlrev_b32 v6, 2, v0
    v_add_u32 v6, 147456, v6
    v_add_u32 v164, s77, v5
    v_add_u32 v165, s78, v6
    s_lshl_b32 s72, s76, 7
    s_and_b32 s72, s72, 0x7800
    s_lshr_b32 s73, s72, 3
    v_add_u32 v140, s72, v5
    v_add_u32 v141, s73, v6
    v_mov_b32 v136, 0
    v_mov_b32 v137, 0
    v_mov_b32 v138, 0
    v_mov_b32 v139, 0
    v_and_b32 v142, 0x1f0, v1
    v_add_u32 v142, 154112, v142
    s_mov_b32 s80, 262144
L_qd:
    ds_read_b32 v104, v4 offset:64
    ds_read_b128 v[160:163], v166 offset:40960
    s_waitcnt lgkmcnt(0)
    v_cmp_gt_u32 vcc, 4, v104
    s_cbranch_vccz L_qd2
    s_sub_u32 s80, s80, 1
    s_cmp_lg_u32 s80, 0
    s_cbranch_scc1 L_qd
L_qd2:
    s_waitcnt vmcnt(23)
    v_mfma_f32_32x32x16_bf16 v[104:119], v[8:11], v[160:163], 0
    ds_write_b128 v164, v[136:139]
    ds_write_b128 v164, v[136:139] offset:1024
    ds_write_b32 v165, v136
    ds_write_b128 v140, v[136:139]
    ds_write_b128 v140, v[136:139] offset:1024
    ds_write_b32 v141, v136
    v_mov_b32 v4, 1
    v_mov_b32 v164, v142
    v_add_u32 v165, 6400, v6
    s_setprio 2
.p2align 6
L_att0:
    s_waitcnt vmcnt(21)
    s_nop 0
    v_exp_f32 v104, v104
    v_mfma_f32_32x32x16_bf16 v[136:151], v[100:103], v[156:159], v[136:151]
    v_exp_f32 v105, v105
    v_exp_f32 v106, v106
    v_exp_f32 v107, v107
    v_exp_f32 v108, v108
    v_mfma_f32_32x32x16_bf16 v[120:135], v[12:15], v[160:163], 0
    v_exp_f32 v109, v109
    v_exp_f32 v110, v110
    v_exp_f32 v111, v111
    v_cvt_pk_bf16_f32 v152, v104, v105
    v_cvt_pk_bf16_f32 v153, v106, v107
    v_cvt_pk_bf16_f32 v154, v108, v109
    v_cvt_pk_bf16_f32 v155, v110, v111
    ds_write_b128 v164, v[136:139]
    v_exp_f32 v112, v112
    v_exp_f32 v113, v113
    ds_write_b128 v164, v[140:143] offset:1024
    v_exp_f32 v114, v114
    v_exp_f32 v115, v115
    ds_write_b32 v165, v144
    ds_add_u32 v2, v167
    v_add_u32 v164, s77, v5
    v_add_u32 v165, s78, v6
    ds_read_b128 v[136:139], v164
    v_exp_f32 v116, v116
    ds_read_b128 v[140:143], v164 offset:1024
    ds_read_b32 v144, v165
    v_exp_f32 v117, v117
    v_exp_f32 v118, v118
    v_exp_f32 v119, v119
    v_cvt_pk_bf16_f32 v156, v112, v113
    v_cvt_pk_bf16_f32 v157, v114, v115
    v_cvt_pk_bf16_f32 v158, v116, v117
    v_cvt_pk_bf16_f32 v159, v118, v119
    s_waitcnt vmcnt(18)
    v_mfma_f32_32x32x16_bf16 v[104:119], v[16:19], v[160:163], 0
    v_exp_f32 v120, v120
    v_exp_f32 v121, v121
    v_exp_f32 v122, v122
    v_exp_f32 v123, v123
    s_waitcnt lgkmcnt(0)
    v_mfma_f32_32x32x16_bf16 v[136:151], v[40:43], v[152:155], v[136:151]
    v_exp_f32 v124, v124
    v_exp_f32 v125, v125
    v_exp_f32 v126, v126
    v_exp_f32 v127, v127
    v_mfma_f32_32x32x16_bf16 v[136:151], v[44:47], v[156:159], v[136:151]
    v_cvt_pk_bf16_f32 v152, v120, v121
    v_cvt_pk_bf16_f32 v153, v122, v123
    v_cvt_pk_bf16_f32 v154, v124, v125
    v_cvt_pk_bf16_f32 v155, v126, v127
    v_exp_f32 v128, v128
    v_exp_f32 v129, v129
    v_mfma_f32_32x32x16_bf16 v[136:151], v[48:51], v[152:155], v[136:151]
    v_exp_f32 v130, v130
    v_exp_f32 v131, v131
    v_exp_f32 v132, v132
    v_exp_f32 v133, v133
    v_exp_f32 v134, v134
    v_exp_f32 v135, v135
    v_cvt_pk_bf16_f32 v156, v128, v129
    v_cvt_pk_bf16_f32 v157, v130, v131
    v_cvt_pk_bf16_f32 v158, v132, v133
    v_cvt_pk_bf16_f32 v159, v134, v135
    s_waitcnt vmcnt(15)
    v_mfma_f32_32x32x16_bf16 v[120:135], v[20:23], v[160:163], 0
    v_exp_f32 v104, v104
    v_exp_f32 v105, v105
    v_exp_f32 v106, v106
    v_exp_f32 v107, v107
    v_mfma_f32_32x32x16_bf16 v[136:151], v[52:55], v[156:159], v[136:151]
    v_exp_f32 v108, v108
    v_exp_f32 v109, v109
    v_exp_f32 v110, v110
    v_exp_f32 v111, v111
    v_cvt_pk_bf16_f32 v152, v104, v105
    v_cvt_pk_bf16_f32 v153, v106, v107
    v_cvt_pk_bf16_f32 v154, v108, v109
    v_cvt_pk_bf16_f32 v155, v110, v111
    v_exp_f32 v112, v112
    v_exp_f32 v113, v113
    v_mfma_f32_32x32x16_bf16 v[136:151], v[56:59], v[152:155], v[136:151]
    v_exp_f32 v114, v114
    v_exp_f32 v115, v115
    v_exp_f32 v116, v116
    v_exp_f32 v117, v117
    v_exp_f32 v118, v118
    v_exp_f32 v119, v119
    v_cvt_pk_bf16_f32 v156, v112, v113
    v_cvt_pk_bf16_f32 v157, v114, v115
    v_cvt_pk_bf16_f32 v158, v116, v117
    v_cvt_pk_bf16_f32 v159, v118, v119
    s_waitcnt vmcnt(12)
    v_mfma_f32_32x32x16_bf16 v[104:119], v[24:27], v[160:163], 0
    v_exp_f32 v120, v120
    v_exp_f32 v121, v121
    v_exp_f32 v122, v122
    v_exp_f32 v123, v123
    v_mfma_f32_32x32x16_bf16 v[136:151], v[60:63], v[156:159], v[136:151]
    v_exp_f32 v124, v124
    v_exp_f32 v125, v125
    v_exp_f32 v126, v126
    v_exp_f32 v127, v127
    v_cvt_pk_bf16_f32 v152, v120, v121
    v_cvt_pk_bf16_f32 v153, v122, v123
    v_cvt_pk_bf16_f32 v154, v124, v125
    v_cvt_pk_bf16_f32 v155, v126, v127
    v_exp_f32 v128, v128
    v_exp_f32 v129, v129
    v_mfma_f32_32x32x16_bf16 v[136:151], v[64:67], v[152:155], v[136:151]
    v_exp_f32 v130, v130
    v_exp_f32 v131, v131
    v_exp_f32 v132, v132
    v_exp_f32 v133, v133
    v_exp_f32 v134, v134
    v_exp_f32 v135, v135
    v_cvt_pk_bf16_f32 v156, v128, v129
    v_cvt_pk_bf16_f32 v157, v130, v131
    v_cvt_pk_bf16_f32 v158, v132, v133
    v_cvt_pk_bf16_f32 v159, v134, v135
    s_waitcnt vmcnt(9)
    v_mfma_f32_32x32x16_bf16 v[120:135], v[28:31], v[160:163], 0
    v_exp_f32 v104, v104
    v_exp_f32 v105, v105
    v_exp_f32 v106, v106
    v_exp_f32 v107, v107
    v_mfma_f32_32x32x16_bf16 v[136:151], v[68:71], v[156:159], v[136:151]
    v_exp_f32 v108, v108
    v_exp_f32 v109, v109
    v_exp_f32 v110, v110
    v_exp_f32 v111, v111
    v_cvt_pk_bf16_f32 v152, v104, v105
    v_cvt_pk_bf16_f32 v153, v106, v107
    v_cvt_pk_bf16_f32 v154, v108, v109
    v_cvt_pk_bf16_f32 v155, v110, v111
    v_exp_f32 v112, v112
    v_exp_f32 v113, v113
    v_mfma_f32_32x32x16_bf16 v[136:151], v[72:75], v[152:155], v[136:151]
    v_exp_f32 v114, v114
    v_exp_f32 v115, v115
    v_exp_f32 v116, v116
    v_exp_f32 v117, v117
    v_exp_f32 v118, v118
    v_exp_f32 v119, v119
    v_cvt_pk_bf16_f32 v156, v112, v113
    v_cvt_pk_bf16_f32 v157, v114, v115
    v_cvt_pk_bf16_f32 v158, v116, v117
    v_cvt_pk_bf16_f32 v159, v118, v119
    s_waitcnt vmcnt(6)
    v_mfma_f32_32x32x16_bf16 v[104:119], v[32:35], v[160:163], 0
    s_lshr_b32 s76, s76, 4
    s_lshl_b32 s72, s76, 10
    s_and_b32 s72, s72, 0x1c00
    v_add_u32 v166, s72, v5
    s_lshl_b32 s77, s76, 11
    s_and_b32 s77, s77, 0x7800
    s_lshr_b32 s78, s77, 3
    v_exp_f32 v120, v120
    v_exp_f32 v121, v121
    v_exp_f32 v122, v122
    v_exp_f32 v123, v123
    v_mfma_f32_32x32x16_bf16 v[136:151], v[76:79], v[156:159], v[136:151]
    v_exp_f32 v124, v124
    v_exp_f32 v125, v125
    v_exp_f32 v126, v126
    v_exp_f32 v127, v127
    v_cvt_pk_bf16_f32 v152, v120, v121
    v_cvt_pk_bf16_f32 v153, v122, v123
    v_cvt_pk_bf16_f32 v154, v124, v125
    v_cvt_pk_bf16_f32 v155, v126, v127
    v_exp_f32 v128, v128
    v_exp_f32 v129, v129
    v_mfma_f32_32x32x16_bf16 v[136:151], v[80:83], v[152:155], v[136:151]
    v_exp_f32 v130, v130
    v_exp_f32 v131, v131
    v_exp_f32 v132, v132
    v_exp_f32 v133, v133
    v_exp_f32 v134, v134
    v_exp_f32 v135, v135
    v_cvt_pk_bf16_f32 v156, v128, v129
    v_cvt_pk_bf16_f32 v157, v130, v131
    v_cvt_pk_bf16_f32 v158, v132, v133
    v_cvt_pk_bf16_f32 v159, v134, v135
    s_waitcnt vmcnt(3)
    v_mfma_f32_32x32x16_bf16 v[120:135], v[36:39], v[160:163], 0
    ds_read_b128 v[160:163], v166 offset:40960
    v_exp_f32 v104, v104
    v_exp_f32 v105, v105
    v_exp_f32 v106, v106
    v_exp_f32 v107, v107
    v_mfma_f32_32x32x16_bf16 v[136:151], v[84:87], v[156:159], v[136:151]
    v_exp_f32 v108, v108
    v_exp_f32 v109, v109
    v_exp_f32 v110, v110
    v_exp_f32 v111, v111
    v_cvt_pk_bf16_f32 v152, v104, v105
    v_cvt_pk_bf16_f32 v153, v106, v107
    v_cvt_pk_bf16_f32 v154, v108, v109
    v_cvt_pk_bf16_f32 v155, v110, v111
    v_exp_f32 v112, v112
    v_exp_f32 v113, v113
    v_mfma_f32_32x32x16_bf16 v[136:151], v[88:91], v[152:155], v[136:151]
    v_exp_f32 v114, v114
    v_exp_f32 v115, v115
    v_exp_f32 v116, v116
    v_exp_f32 v117, v117
    v_exp_f32 v118, v118
    v_exp_f32 v119, v119
    v_cvt_pk_bf16_f32 v156, v112, v113
    v_cvt_pk_bf16_f32 v157, v114, v115
    v_cvt_pk_bf16_f32 v158, v116, v117
    v_cvt_pk_bf16_f32 v159, v118, v119
    s_waitcnt lgkmcnt(0)
    s_waitcnt vmcnt(0)
    v_mfma_f32_32x32x16_bf16 v[104:119], v[8:11], v[160:163], 0
    v_exp_f32 v120, v120
    v_exp_f32 v121, v121
    v_exp_f32 v122, v122
    v_exp_f32 v123, v123
    v_mfma_f32_32x32x16_bf16 v[136:151], v[92:95], v[156:159], v[136:151]
    v_exp_f32 v124, v124
    v_exp_f32 v125, v125
    v_exp_f32 v126, v126
    v_exp_f32 v127, v127
    v_cvt_pk_bf16_f32 v152, v120, v121
    v_cvt_pk_bf16_f32 v153, v122, v123
    v_cvt_pk_bf16_f32 v154, v124, v125
    v_cvt_pk_bf16_f32 v155, v126, v127
    v_exp_f32 v128, v128
    v_exp_f32 v129, v129
    v_mfma_f32_32x32x16_bf16 v[136:151], v[96:99], v[152:155], v[136:151]
    v_exp_f32 v130, v130
    v_exp_f32 v131, v131
    v_exp_f32 v132, v132
    v_exp_f32 v133, v133
    v_exp_f32 v134, v134
    v_exp_f32 v135, v135
    s_add_u32 s81, s81, 1
    s_cmp_lt_u32 s81, 1
    v_cvt_pk_bf16_f32 v156, v128, v129
    v_cvt_pk_bf16_f32 v157, v130, v131
    v_cvt_pk_bf16_f32 v158, v132, v133
    v_cvt_pk_bf16_f32 v159, v134, v135
    s_nop 0
    s_branch L_att1
L_blk1:
    s_mov_b32 s80, 262144
L_blkl1:
    s_sleep 2
    ds_read_b32 v4, v3
    s_waitcnt lgkmcnt(0)
    v_readlane_b32 s83, v4, 0
    s_nop 0
    s_cmp_ge_u32 s83, s81
    s_cbranch_scc1 L_blkb1
    s_sub_u32 s80, s80, 1
    s_cmp_lg_u32 s80, 0
    s_cbranch_scc1 L_blkl1
    s_branch L_blkb1

L_att1:
    v_exp_f32 v104, v104
    v_mfma_f32_32x32x16_bf16 v[136:151], v[100:103], v[156:159], v[136:151]
    v_exp_f32 v105, v105
    v_exp_f32 v106, v106
    v_exp_f32 v107, v107
    v_exp_f32 v108, v108
    v_mfma_f32_32x32x16_bf16 v[120:135], v[12:15], v[160:163], 0
    v_exp_f32 v109, v109
    v_exp_f32 v110, v110
    v_exp_f32 v111, v111
    v_cvt_pk_bf16_f32 v152, v104, v105
    v_cvt_pk_bf16_f32 v153, v106, v107
    v_cvt_pk_bf16_f32 v154, v108, v109
    v_cvt_pk_bf16_f32 v155, v110, v111
    v_readlane_b32 s83, v4, 0
    ds_write_b128 v164, v[136:139]
    v_exp_f32 v112, v112
    v_exp_f32 v113, v113
    ds_write_b128 v164, v[140:143] offset:1024
    v_exp_f32 v114, v114
    v_exp_f32 v115, v115
    ds_write_b32 v165, v144
    ds_add_u32 v2, v167
    v_add_u32 v164, s77, v5
    v_add_u32 v165, s78, v6
    s_cmp_lt_u32 s83, s81
    s_cbranch_scc1 L_blk1
L_blkb1:
    ds_read_b128 v[136:139], v164
    v_exp_f32 v116, v116
    ds_read_b128 v[140:143], v164 offset:1024
    ds_read_b32 v144, v165
    v_exp_f32 v117, v117
    v_exp_f32 v118, v118
    v_exp_f32 v119, v119
    v_cvt_pk_bf16_f32 v156, v112, v113
    v_cvt_pk_bf16_f32 v157, v114, v115
    v_cvt_pk_bf16_f32 v158, v116, v117
    v_cvt_pk_bf16_f32 v159, v118, v119
    v_mfma_f32_32x32x16_bf16 v[104:119], v[16:19], v[160:163], 0
    v_exp_f32 v120, v120
    v_exp_f32 v121, v121
    v_exp_f32 v122, v122
    v_exp_f32 v123, v123
    s_waitcnt lgkmcnt(0)
    v_mfma_f32_32x32x16_bf16 v[136:151], v[40:43], v[152:155], v[136:151]
    v_exp_f32 v124, v124
    v_exp_f32 v125, v125
    v_exp_f32 v126, v126
    v_exp_f32 v127, v127
    v_mfma_f32_32x32x16_bf16 v[136:151], v[44:47], v[156:159], v[136:151]
    v_cvt_pk_bf16_f32 v152, v120, v121
    v_cvt_pk_bf16_f32 v153, v122, v123
    v_cvt_pk_bf16_f32 v154, v124, v125
    v_cvt_pk_bf16_f32 v155, v126, v127
    v_exp_f32 v128, v128
    v_exp_f32 v129, v129
    v_mfma_f32_32x32x16_bf16 v[136:151], v[48:51], v[152:155], v[136:151]
    v_exp_f32 v130, v130
    v_exp_f32 v131, v131
    v_exp_f32 v132, v132
    v_exp_f32 v133, v133
    v_exp_f32 v134, v134
    v_exp_f32 v135, v135
    v_cvt_pk_bf16_f32 v156, v128, v129
    v_cvt_pk_bf16_f32 v157, v130, v131
    v_cvt_pk_bf16_f32 v158, v132, v133
    v_cvt_pk_bf16_f32 v159, v134, v135
    v_mfma_f32_32x32x16_bf16 v[120:135], v[20:23], v[160:163], 0
    v_exp_f32 v104, v104
    v_exp_f32 v105, v105
    v_exp_f32 v106, v106
    v_exp_f32 v107, v107
    v_mfma_f32_32x32x16_bf16 v[136:151], v[52:55], v[156:159], v[136:151]
    v_exp_f32 v108, v108
    v_exp_f32 v109, v109
    v_exp_f32 v110, v110
    v_exp_f32 v111, v111
    v_cvt_pk_bf16_f32 v152, v104, v105
    v_cvt_pk_bf16_f32 v153, v106, v107
    v_cvt_pk_bf16_f32 v154, v108, v109
    v_cvt_pk_bf16_f32 v155, v110, v111
    v_exp_f32 v112, v112
    v_exp_f32 v113, v113
    v_mfma_f32_32x32x16_bf16 v[136:151], v[56:59], v[152:155], v[136:151]
    v_exp_f32 v114, v114
    v_exp_f32 v115, v115
    v_exp_f32 v116, v116
    v_exp_f32 v117, v117
    v_exp_f32 v118, v118
    v_exp_f32 v119, v119
    v_cvt_pk_bf16_f32 v156, v112, v113
    v_cvt_pk_bf16_f32 v157, v114, v115
    v_cvt_pk_bf16_f32 v158, v116, v117
    v_cvt_pk_bf16_f32 v159, v118, v119
    v_mfma_f32_32x32x16_bf16 v[104:119], v[24:27], v[160:163], 0
    v_exp_f32 v120, v120
    v_exp_f32 v121, v121
    v_exp_f32 v122, v122
    v_exp_f32 v123, v123
    v_mfma_f32_32x32x16_bf16 v[136:151], v[60:63], v[156:159], v[136:151]
    v_exp_f32 v124, v124
    v_exp_f32 v125, v125
    v_exp_f32 v126, v126
    v_exp_f32 v127, v127
    v_cvt_pk_bf16_f32 v152, v120, v121
    v_cvt_pk_bf16_f32 v153, v122, v123
    v_cvt_pk_bf16_f32 v154, v124, v125
    v_cvt_pk_bf16_f32 v155, v126, v127
    v_exp_f32 v128, v128
    v_exp_f32 v129, v129
    v_mfma_f32_32x32x16_bf16 v[136:151], v[64:67], v[152:155], v[136:151]
    v_exp_f32 v130, v130
    v_exp_f32 v131, v131
    v_exp_f32 v132, v132
    v_exp_f32 v133, v133
    v_exp_f32 v134, v134
    v_exp_f32 v135, v135
    v_cvt_pk_bf16_f32 v156, v128, v129
    v_cvt_pk_bf16_f32 v157, v130, v131
    v_cvt_pk_bf16_f32 v158, v132, v133
    v_cvt_pk_bf16_f32 v159, v134, v135
    v_mfma_f32_32x32x16_bf16 v[120:135], v[28:31], v[160:163], 0
    v_exp_f32 v104, v104
    v_exp_f32 v105, v105
    v_exp_f32 v106, v106
    v_exp_f32 v107, v107
    v_mfma_f32_32x32x16_bf16 v[136:151], v[68:71], v[156:159], v[136:151]
    v_exp_f32 v108, v108
    v_exp_f32 v109, v109
    v_exp_f32 v110, v110
    v_exp_f32 v111, v111
    v_cvt_pk_bf16_f32 v152, v104, v105
    v_cvt_pk_bf16_f32 v153, v106, v107
    v_cvt_pk_bf16_f32 v154, v108, v109
    v_cvt_pk_bf16_f32 v155, v110, v111
    v_exp_f32 v112, v112
    v_exp_f32 v113, v113
    v_mfma_f32_32x32x16_bf16 v[136:151], v[72:75], v[152:155], v[136:151]
    v_exp_f32 v114, v114
    v_exp_f32 v115, v115
    v_exp_f32 v116, v116
    v_exp_f32 v117, v117
    v_exp_f32 v118, v118
    v_exp_f32 v119, v119
    v_cvt_pk_bf16_f32 v156, v112, v113
    v_cvt_pk_bf16_f32 v157, v114, v115
    v_cvt_pk_bf16_f32 v158, v116, v117
    v_cvt_pk_bf16_f32 v159, v118, v119
    v_mfma_f32_32x32x16_bf16 v[104:119], v[32:35], v[160:163], 0
    s_lshr_b32 s76, s76, 4
    s_lshl_b32 s72, s76, 10
    s_and_b32 s72, s72, 0x1c00
    v_add_u32 v166, s72, v5
    s_lshl_b32 s77, s76, 11
    s_and_b32 s77, s77, 0x7800
    s_lshr_b32 s78, s77, 3
    v_exp_f32 v120, v120
    v_exp_f32 v121, v121
    v_exp_f32 v122, v122
    v_exp_f32 v123, v123
    v_mfma_f32_32x32x16_bf16 v[136:151], v[76:79], v[156:159], v[136:151]
    v_exp_f32 v124, v124
    v_exp_f32 v125, v125
    v_exp_f32 v126, v126
    v_exp_f32 v127, v127
    v_cvt_pk_bf16_f32 v152, v120, v121
    v_cvt_pk_bf16_f32 v153, v122, v123
    v_cvt_pk_bf16_f32 v154, v124, v125
    v_cvt_pk_bf16_f32 v155, v126, v127
    v_exp_f32 v128, v128
    v_exp_f32 v129, v129
    v_mfma_f32_32x32x16_bf16 v[136:151], v[80:83], v[152:155], v[136:151]
    v_exp_f32 v130, v130
    v_exp_f32 v131, v131
    v_exp_f32 v132, v132
    v_exp_f32 v133, v133
    v_exp_f32 v134, v134
    v_exp_f32 v135, v135
    v_cvt_pk_bf16_f32 v156, v128, v129
    v_cvt_pk_bf16_f32 v157, v130, v131
    v_cvt_pk_bf16_f32 v158, v132, v133
    v_cvt_pk_bf16_f32 v159, v134, v135
    v_mfma_f32_32x32x16_bf16 v[120:135], v[36:39], v[160:163], 0
    ds_read_b128 v[160:163], v166 offset:40960
    ds_read_b32 v4, v3
    v_exp_f32 v104, v104
    v_exp_f32 v105, v105
    v_exp_f32 v106, v106
    v_exp_f32 v107, v107
    v_mfma_f32_32x32x16_bf16 v[136:151], v[84:87], v[156:159], v[136:151]
    v_exp_f32 v108, v108
    v_exp_f32 v109, v109
    v_exp_f32 v110, v110
    v_exp_f32 v111, v111
    v_cvt_pk_bf16_f32 v152, v104, v105
    v_cvt_pk_bf16_f32 v153, v106, v107
    v_cvt_pk_bf16_f32 v154, v108, v109
    v_cvt_pk_bf16_f32 v155, v110, v111
    v_exp_f32 v112, v112
    v_exp_f32 v113, v113
    v_mfma_f32_32x32x16_bf16 v[136:151], v[88:91], v[152:155], v[136:151]
    v_exp_f32 v114, v114
    v_exp_f32 v115, v115
    v_exp_f32 v116, v116
    v_exp_f32 v117, v117
    v_exp_f32 v118, v118
    v_exp_f32 v119, v119
    v_cvt_pk_bf16_f32 v156, v112, v113
    v_cvt_pk_bf16_f32 v157, v114, v115
    v_cvt_pk_bf16_f32 v158, v116, v117
    v_cvt_pk_bf16_f32 v159, v118, v119
    s_waitcnt lgkmcnt(0)
    v_mfma_f32_32x32x16_bf16 v[104:119], v[8:11], v[160:163], 0
    v_exp_f32 v120, v120
    v_exp_f32 v121, v121
    v_exp_f32 v122, v122
    v_exp_f32 v123, v123
    v_mfma_f32_32x32x16_bf16 v[136:151], v[92:95], v[156:159], v[136:151]
    v_exp_f32 v124, v124
    v_exp_f32 v125, v125
    v_exp_f32 v126, v126
    v_exp_f32 v127, v127
    v_cvt_pk_bf16_f32 v152, v120, v121
    v_cvt_pk_bf16_f32 v153, v122, v123
    v_cvt_pk_bf16_f32 v154, v124, v125
    v_cvt_pk_bf16_f32 v155, v126, v127
    v_exp_f32 v128, v128
    v_exp_f32 v129, v129
    v_mfma_f32_32x32x16_bf16 v[136:151], v[96:99], v[152:155], v[136:151]
    v_exp_f32 v130, v130
    v_exp_f32 v131, v131
    v_exp_f32 v132, v132
    v_exp_f32 v133, v133
    v_exp_f32 v134, v134
    v_exp_f32 v135, v135
    s_add_u32 s81, s81, 1
    s_cmp_lt_u32 s81, 3
    v_cvt_pk_bf16_f32 v156, v128, v129
    v_cvt_pk_bf16_f32 v157, v130, v131
    v_cvt_pk_bf16_f32 v158, v132, v133
    v_cvt_pk_bf16_f32 v159, v134, v135
    s_cbranch_scc1 L_att1
    s_nop 0
    s_branch L_att2
L_blk2:
    s_mov_b32 s80, 262144
L_blkl2:
    s_sleep 2
    ds_read_b32 v4, v3
    s_waitcnt lgkmcnt(0)
    v_readlane_b32 s83, v4, s84
    s_nop 0
    s_cmp_ge_u32 s83, s81
    s_cbranch_scc1 L_blkb2
    s_sub_u32 s80, s80, 1
    s_cmp_lg_u32 s80, 0
    s_cbranch_scc1 L_blkl2
    s_branch L_blkb2

L_att2:
    v_exp_f32 v104, v104
    v_mfma_f32_32x32x16_bf16 v[136:151], v[100:103], v[156:159], v[136:151]
    v_exp_f32 v105, v105
    v_exp_f32 v106, v106
    v_exp_f32 v107, v107
    v_exp_f32 v108, v108
    v_mfma_f32_32x32x16_bf16 v[120:135], v[12:15], v[160:163], 0
    v_exp_f32 v109, v109
    v_exp_f32 v110, v110
    v_exp_f32 v111, v111
    v_cvt_pk_bf16_f32 v152, v104, v105
    v_cvt_pk_bf16_f32 v153, v106, v107
    v_cvt_pk_bf16_f32 v154, v108, v109
    v_cvt_pk_bf16_f32 v155, v110, v111
    v_readlane_b32 s83, v4, s84
    ds_write_b128 v164, v[136:139]
    v_exp_f32 v112, v112
    v_exp_f32 v113, v113
    ds_write_b128 v164, v[140:143] offset:1024
    v_exp_f32 v114, v114
    v_exp_f32 v115, v115
    ds_write_b32 v165, v144
    ds_add_u32 v2, v167
    s_setprio 1
    v_add_u32 v164, s77, v5
    v_add_u32 v165, s78, v6
    s_cmp_lt_u32 s83, s81
    s_cbranch_scc1 L_blk2
L_blkb2:
    ds_read_b128 v[136:139], v164
    v_exp_f32 v116, v116
    ds_read_b128 v[140:143], v164 offset:1024
    ds_read_b32 v144, v165
    v_exp_f32 v117, v117
    v_exp_f32 v118, v118
    v_exp_f32 v119, v119
    v_cvt_pk_bf16_f32 v156, v112, v113
    v_cvt_pk_bf16_f32 v157, v114, v115
    v_cvt_pk_bf16_f32 v158, v116, v117
    v_cvt_pk_bf16_f32 v159, v118, v119
    v_mfma_f32_32x32x16_bf16 v[104:119], v[16:19], v[160:163], 0
    v_exp_f32 v120, v120
    v_exp_f32 v121, v121
    v_exp_f32 v122, v122
    v_exp_f32 v123, v123
    s_waitcnt lgkmcnt(0)
    v_mfma_f32_32x32x16_bf16 v[136:151], v[40:43], v[152:155], v[136:151]
    v_exp_f32 v124, v124
    v_exp_f32 v125, v125
    v_exp_f32 v126, v126
    v_exp_f32 v127, v127
    v_mfma_f32_32x32x16_bf16 v[136:151], v[44:47], v[156:159], v[136:151]
    v_cvt_pk_bf16_f32 v152, v120, v121
    v_cvt_pk_bf16_f32 v153, v122, v123
    v_cvt_pk_bf16_f32 v154, v124, v125
    v_cvt_pk_bf16_f32 v155, v126, v127
    v_exp_f32 v128, v128
    v_exp_f32 v129, v129
    v_mfma_f32_32x32x16_bf16 v[136:151], v[48:51], v[152:155], v[136:151]
    v_exp_f32 v130, v130
    v_exp_f32 v131, v131
    v_exp_f32 v132, v132
    v_exp_f32 v133, v133
    v_exp_f32 v134, v134
    v_exp_f32 v135, v135
    v_cvt_pk_bf16_f32 v156, v128, v129
    v_cvt_pk_bf16_f32 v157, v130, v131
    v_cvt_pk_bf16_f32 v158, v132, v133
    v_cvt_pk_bf16_f32 v159, v134, v135
    v_mfma_f32_32x32x16_bf16 v[120:135], v[20:23], v[160:163], 0
    v_exp_f32 v104, v104
    v_exp_f32 v105, v105
    v_exp_f32 v106, v106
    v_exp_f32 v107, v107
    v_mfma_f32_32x32x16_bf16 v[136:151], v[52:55], v[156:159], v[136:151]
    v_exp_f32 v108, v108
    v_exp_f32 v109, v109
    v_exp_f32 v110, v110
    v_exp_f32 v111, v111
    v_cvt_pk_bf16_f32 v152, v104, v105
    v_cvt_pk_bf16_f32 v153, v106, v107
    v_cvt_pk_bf16_f32 v154, v108, v109
    v_cvt_pk_bf16_f32 v155, v110, v111
    v_exp_f32 v112, v112
    v_exp_f32 v113, v113
    v_mfma_f32_32x32x16_bf16 v[136:151], v[56:59], v[152:155], v[136:151]
    v_exp_f32 v114, v114
    v_exp_f32 v115, v115
    v_exp_f32 v116, v116
    v_exp_f32 v117, v117
    v_exp_f32 v118, v118
    v_exp_f32 v119, v119
    v_cvt_pk_bf16_f32 v156, v112, v113
    v_cvt_pk_bf16_f32 v157, v114, v115
    v_cvt_pk_bf16_f32 v158, v116, v117
    v_cvt_pk_bf16_f32 v159, v118, v119
    v_mfma_f32_32x32x16_bf16 v[104:119], v[24:27], v[160:163], 0
    v_exp_f32 v120, v120
    v_exp_f32 v121, v121
    v_exp_f32 v122, v122
    v_exp_f32 v123, v123
    v_mfma_f32_32x32x16_bf16 v[136:151], v[60:63], v[156:159], v[136:151]
    v_exp_f32 v124, v124
    v_exp_f32 v125, v125
    v_exp_f32 v126, v126
    v_exp_f32 v127, v127
    v_cvt_pk_bf16_f32 v152, v120, v121
    v_cvt_pk_bf16_f32 v153, v122, v123
    v_cvt_pk_bf16_f32 v154, v124, v125
    v_cvt_pk_bf16_f32 v155, v126, v127
    v_exp_f32 v128, v128
    v_exp_f32 v129, v129
    v_mfma_f32_32x32x16_bf16 v[136:151], v[64:67], v[152:155], v[136:151]
    v_exp_f32 v130, v130
    v_exp_f32 v131, v131
    v_exp_f32 v132, v132
    v_exp_f32 v133, v133
    v_exp_f32 v134, v134
    v_exp_f32 v135, v135
    v_cvt_pk_bf16_f32 v156, v128, v129
    v_cvt_pk_bf16_f32 v157, v130, v131
    v_cvt_pk_bf16_f32 v158, v132, v133
    v_cvt_pk_bf16_f32 v159, v134, v135
    v_mfma_f32_32x32x16_bf16 v[120:135], v[28:31], v[160:163], 0
    v_exp_f32 v104, v104
    v_exp_f32 v105, v105
    v_exp_f32 v106, v106
    v_exp_f32 v107, v107
    v_mfma_f32_32x32x16_bf16 v[136:151], v[68:71], v[156:159], v[136:151]
    v_exp_f32 v108, v108
    v_exp_f32 v109, v109
    v_exp_f32 v110, v110
    v_exp_f32 v111, v111
    v_cvt_pk_bf16_f32 v152, v104, v105
    v_cvt_pk_bf16_f32 v153, v106, v107
    v_cvt_pk_bf16_f32 v154, v108, v109
    v_cvt_pk_bf16_f32 v155, v110, v111
    v_exp_f32 v112, v112
    v_exp_f32 v113, v113
    v_mfma_f32_32x32x16_bf16 v[136:151], v[72:75], v[152:155], v[136:151]
    v_exp_f32 v114, v114
    v_exp_f32 v115, v115
    v_exp_f32 v116, v116
    v_exp_f32 v117, v117
    v_exp_f32 v118, v118
    v_exp_f32 v119, v119
    v_cvt_pk_bf16_f32 v156, v112, v113
    v_cvt_pk_bf16_f32 v157, v114, v115
    v_cvt_pk_bf16_f32 v158, v116, v117
    v_cvt_pk_bf16_f32 v159, v118, v119
    v_mfma_f32_32x32x16_bf16 v[104:119], v[32:35], v[160:163], 0
    s_lshr_b32 s76, s76, 4
    s_lshl_b32 s72, s76, 10
    s_and_b32 s72, s72, 0x1c00
    v_add_u32 v166, s72, v5
    s_lshl_b32 s77, s76, 11
    s_and_b32 s77, s77, 0x7800
    s_lshr_b32 s78, s77, 3
    v_exp_f32 v120, v120
    v_exp_f32 v121, v121
    v_exp_f32 v122, v122
    v_exp_f32 v123, v123
    v_mfma_f32_32x32x16_bf16 v[136:151], v[76:79], v[156:159], v[136:151]
    v_exp_f32 v124, v124
    v_exp_f32 v125, v125
    v_exp_f32 v126, v126
    v_exp_f32 v127, v127
    v_cvt_pk_bf16_f32 v152, v120, v121
    v_cvt_pk_bf16_f32 v153, v122, v123
    v_cvt_pk_bf16_f32 v154, v124, v125
    v_cvt_pk_bf16_f32 v155, v126, v127
    v_exp_f32 v128, v128
    v_exp_f32 v129, v129
    v_mfma_f32_32x32x16_bf16 v[136:151], v[80:83], v[152:155], v[136:151]
    v_exp_f32 v130, v130
    v_exp_f32 v131, v131
    v_exp_f32 v132, v132
    v_exp_f32 v133, v133
    v_exp_f32 v134, v134
    v_exp_f32 v135, v135
    v_cvt_pk_bf16_f32 v156, v128, v129
    v_cvt_pk_bf16_f32 v157, v130, v131
    v_cvt_pk_bf16_f32 v158, v132, v133
    v_cvt_pk_bf16_f32 v159, v134, v135
    v_mfma_f32_32x32x16_bf16 v[120:135], v[36:39], v[160:163], 0
    ds_read_b128 v[160:163], v166 offset:40960
    ds_read_b32 v4, v3
    v_exp_f32 v104, v104
    v_exp_f32 v105, v105
    v_exp_f32 v106, v106
    v_exp_f32 v107, v107
    v_mfma_f32_32x32x16_bf16 v[136:151], v[84:87], v[156:159], v[136:151]
    v_exp_f32 v108, v108
    v_exp_f32 v109, v109
    v_exp_f32 v110, v110
    v_exp_f32 v111, v111
    v_cvt_pk_bf16_f32 v152, v104, v105
    v_cvt_pk_bf16_f32 v153, v106, v107
    v_cvt_pk_bf16_f32 v154, v108, v109
    v_cvt_pk_bf16_f32 v155, v110, v111
    v_exp_f32 v112, v112
    v_exp_f32 v113, v113
    v_mfma_f32_32x32x16_bf16 v[136:151], v[88:91], v[152:155], v[136:151]
    v_exp_f32 v114, v114
    v_exp_f32 v115, v115
    v_exp_f32 v116, v116
    v_exp_f32 v117, v117
    v_exp_f32 v118, v118
    v_exp_f32 v119, v119
    v_cvt_pk_bf16_f32 v156, v112, v113
    v_cvt_pk_bf16_f32 v157, v114, v115
    v_cvt_pk_bf16_f32 v158, v116, v117
    v_cvt_pk_bf16_f32 v159, v118, v119
    s_waitcnt lgkmcnt(0)
    v_mfma_f32_32x32x16_bf16 v[104:119], v[8:11], v[160:163], 0
    v_exp_f32 v120, v120
    v_exp_f32 v121, v121
    v_exp_f32 v122, v122
    v_exp_f32 v123, v123
    v_mfma_f32_32x32x16_bf16 v[136:151], v[92:95], v[156:159], v[136:151]
    v_exp_f32 v124, v124
    v_exp_f32 v125, v125
    v_exp_f32 v126, v126
    v_exp_f32 v127, v127
    v_cvt_pk_bf16_f32 v152, v120, v121
    v_cvt_pk_bf16_f32 v153, v122, v123
    v_cvt_pk_bf16_f32 v154, v124, v125
    v_cvt_pk_bf16_f32 v155, v126, v127
    v_exp_f32 v128, v128
    v_exp_f32 v129, v129
    v_mfma_f32_32x32x16_bf16 v[136:151], v[96:99], v[152:155], v[136:151]
    v_exp_f32 v130, v130
    v_exp_f32 v131, v131
    v_exp_f32 v132, v132
    v_exp_f32 v133, v133
    v_exp_f32 v134, v134
    v_exp_f32 v135, v135
    s_lshr_b32 s84, s84, 1
    s_add_u32 s81, s81, 1
    s_cmp_lt_u32 s81, 7
    v_cvt_pk_bf16_f32 v156, v128, v129
    v_cvt_pk_bf16_f32 v157, v130, v131
    v_cvt_pk_bf16_f32 v158, v132, v133
    v_cvt_pk_bf16_f32 v159, v134, v135
    s_cbranch_scc1 L_att2
    s_nop 0
    s_branch L_att3
L_blk3:
    s_mov_b32 s80, 262144
L_blkl3:
    s_sleep 2
    ds_read_b32 v4, v3
    s_waitcnt lgkmcnt(0)
    v_readlane_b32 s83, v4, 0
    s_nop 0
    s_cmp_ge_u32 s83, s81
    s_cbranch_scc1 L_blkb3
    s_sub_u32 s80, s80, 1
    s_cmp_lg_u32 s80, 0
    s_cbranch_scc1 L_blkl3
    s_branch L_blkb3

L_att3:
    v_exp_f32 v104, v104
    v_mfma_f32_32x32x16_bf16 v[136:151], v[100:103], v[156:159], v[136:151]
    v_exp_f32 v105, v105
    v_exp_f32 v106, v106
    v_exp_f32 v107, v107
    v_exp_f32 v108, v108
    v_mfma_f32_32x32x16_bf16 v[120:135], v[12:15], v[160:163], 0
    v_exp_f32 v109, v109
    v_exp_f32 v110, v110
    v_exp_f32 v111, v111
    v_cvt_pk_bf16_f32 v152, v104, v105
    v_cvt_pk_bf16_f32 v153, v106, v107
    v_cvt_pk_bf16_f32 v154, v108, v109
    v_cvt_pk_bf16_f32 v155, v110, v111
    v_readlane_b32 s83, v4, 0
    ds_write_b128 v164, v[136:139]
    v_exp_f32 v112, v112
    v_exp_f32 v113, v113
    ds_write_b128 v164, v[140:143] offset:1024
    v_exp_f32 v114, v114
    v_exp_f32 v115, v115
    ds_write_b32 v165, v144
    ds_add_u32 v2, v167
    s_setprio 0
    v_add_u32 v164, s77, v5
    v_add_u32 v165, s78, v6
    s_cmp_lt_u32 s83, s81
    s_cbranch_scc1 L_blk3
L_blkb3:
    ds_read_b128 v[136:139], v164
    v_exp_f32 v116, v116
    ds_read_b128 v[140:143], v164 offset:1024
    ds_read_b32 v144, v165
    v_exp_f32 v117, v117
    v_exp_f32 v118, v118
    v_exp_f32 v119, v119
    v_cvt_pk_bf16_f32 v156, v112, v113
    v_cvt_pk_bf16_f32 v157, v114, v115
    v_cvt_pk_bf16_f32 v158, v116, v117
    v_cvt_pk_bf16_f32 v159, v118, v119
    v_mfma_f32_32x32x16_bf16 v[104:119], v[16:19], v[160:163], 0
    v_exp_f32 v120, v120
    v_exp_f32 v121, v121
    v_exp_f32 v122, v122
    v_exp_f32 v123, v123
    s_waitcnt lgkmcnt(0)
    v_mfma_f32_32x32x16_bf16 v[136:151], v[40:43], v[152:155], v[136:151]
    v_exp_f32 v124, v124
    v_exp_f32 v125, v125
    v_exp_f32 v126, v126
    v_exp_f32 v127, v127
    v_mfma_f32_32x32x16_bf16 v[136:151], v[44:47], v[156:159], v[136:151]
    v_cvt_pk_bf16_f32 v152, v120, v121
    v_cvt_pk_bf16_f32 v153, v122, v123
    v_cvt_pk_bf16_f32 v154, v124, v125
    v_cvt_pk_bf16_f32 v155, v126, v127
    v_exp_f32 v128, v128
    v_exp_f32 v129, v129
    v_mfma_f32_32x32x16_bf16 v[136:151], v[48:51], v[152:155], v[136:151]
    v_exp_f32 v130, v130
    v_exp_f32 v131, v131
    v_exp_f32 v132, v132
    v_exp_f32 v133, v133
    v_exp_f32 v134, v134
    v_exp_f32 v135, v135
    v_cvt_pk_bf16_f32 v156, v128, v129
    v_cvt_pk_bf16_f32 v157, v130, v131
    v_cvt_pk_bf16_f32 v158, v132, v133
    v_cvt_pk_bf16_f32 v159, v134, v135
    v_mfma_f32_32x32x16_bf16 v[120:135], v[20:23], v[160:163], 0
    v_exp_f32 v104, v104
    v_exp_f32 v105, v105
    v_exp_f32 v106, v106
    v_exp_f32 v107, v107
    v_mfma_f32_32x32x16_bf16 v[136:151], v[52:55], v[156:159], v[136:151]
    v_exp_f32 v108, v108
    v_exp_f32 v109, v109
    v_exp_f32 v110, v110
    v_exp_f32 v111, v111
    v_cvt_pk_bf16_f32 v152, v104, v105
    v_cvt_pk_bf16_f32 v153, v106, v107
    v_cvt_pk_bf16_f32 v154, v108, v109
    v_cvt_pk_bf16_f32 v155, v110, v111
    v_exp_f32 v112, v112
    v_exp_f32 v113, v113
    v_mfma_f32_32x32x16_bf16 v[136:151], v[56:59], v[152:155], v[136:151]
    v_exp_f32 v114, v114
    v_exp_f32 v115, v115
    v_exp_f32 v116, v116
    v_exp_f32 v117, v117
    v_exp_f32 v118, v118
    v_exp_f32 v119, v119
    v_cvt_pk_bf16_f32 v156, v112, v113
    v_cvt_pk_bf16_f32 v157, v114, v115
    v_cvt_pk_bf16_f32 v158, v116, v117
    v_cvt_pk_bf16_f32 v159, v118, v119
    v_mfma_f32_32x32x16_bf16 v[104:119], v[24:27], v[160:163], 0
    v_exp_f32 v120, v120
    v_exp_f32 v121, v121
    v_exp_f32 v122, v122
    v_exp_f32 v123, v123
    v_mfma_f32_32x32x16_bf16 v[136:151], v[60:63], v[156:159], v[136:151]
    v_exp_f32 v124, v124
    v_exp_f32 v125, v125
    v_exp_f32 v126, v126
    v_exp_f32 v127, v127
    v_cvt_pk_bf16_f32 v152, v120, v121
    v_cvt_pk_bf16_f32 v153, v122, v123
    v_cvt_pk_bf16_f32 v154, v124, v125
    v_cvt_pk_bf16_f32 v155, v126, v127
    v_exp_f32 v128, v128
    v_exp_f32 v129, v129
    v_mfma_f32_32x32x16_bf16 v[136:151], v[64:67], v[152:155], v[136:151]
    v_exp_f32 v130, v130
    v_exp_f32 v131, v131
    v_exp_f32 v132, v132
    v_exp_f32 v133, v133
    v_exp_f32 v134, v134
    v_exp_f32 v135, v135
    v_cvt_pk_bf16_f32 v156, v128, v129
    v_cvt_pk_bf16_f32 v157, v130, v131
    v_cvt_pk_bf16_f32 v158, v132, v133
    v_cvt_pk_bf16_f32 v159, v134, v135
    v_mfma_f32_32x32x16_bf16 v[120:135], v[28:31], v[160:163], 0
    v_exp_f32 v104, v104
    v_exp_f32 v105, v105
    v_exp_f32 v106, v106
    v_exp_f32 v107, v107
    v_mfma_f32_32x32x16_bf16 v[136:151], v[68:71], v[156:159], v[136:151]
    v_exp_f32 v108, v108
    v_exp_f32 v109, v109
    v_exp_f32 v110, v110
    v_exp_f32 v111, v111
    v_cvt_pk_bf16_f32 v152, v104, v105
    v_cvt_pk_bf16_f32 v153, v106, v107
    v_cvt_pk_bf16_f32 v154, v108, v109
    v_cvt_pk_bf16_f32 v155, v110, v111
    v_exp_f32 v112, v112
    v_exp_f32 v113, v113
    v_mfma_f32_32x32x16_bf16 v[136:151], v[72:75], v[152:155], v[136:151]
    v_exp_f32 v114, v114
    v_exp_f32 v115, v115
    v_exp_f32 v116, v116
    v_exp_f32 v117, v117
    v_exp_f32 v118, v118
    v_exp_f32 v119, v119
    v_cvt_pk_bf16_f32 v156, v112, v113
    v_cvt_pk_bf16_f32 v157, v114, v115
    v_cvt_pk_bf16_f32 v158, v116, v117
    v_cvt_pk_bf16_f32 v159, v118, v119
    v_mfma_f32_32x32x16_bf16 v[104:119], v[32:35], v[160:163], 0
    v_exp_f32 v120, v120
    v_exp_f32 v121, v121
    v_exp_f32 v122, v122
    v_exp_f32 v123, v123
    v_mfma_f32_32x32x16_bf16 v[136:151], v[76:79], v[156:159], v[136:151]
    v_exp_f32 v124, v124
    v_exp_f32 v125, v125
    v_exp_f32 v126, v126
    v_exp_f32 v127, v127
    v_cvt_pk_bf16_f32 v152, v120, v121
    v_cvt_pk_bf16_f32 v153, v122, v123
    v_cvt_pk_bf16_f32 v154, v124, v125
    v_cvt_pk_bf16_f32 v155, v126, v127
    v_exp_f32 v128, v128
    v_exp_f32 v129, v129
    v_mfma_f32_32x32x16_bf16 v[136:151], v[80:83], v[152:155], v[136:151]
    v_exp_f32 v130, v130
    v_exp_f32 v131, v131
    v_exp_f32 v132, v132
    v_exp_f32 v133, v133
    v_exp_f32 v134, v134
    v_exp_f32 v135, v135
    v_cvt_pk_bf16_f32 v156, v128, v129
    v_cvt_pk_bf16_f32 v157, v130, v131
    v_cvt_pk_bf16_f32 v158, v132, v133
    v_cvt_pk_bf16_f32 v159, v134, v135
    v_mfma_f32_32x32x16_bf16 v[120:135], v[36:39], v[160:163], 0
    v_exp_f32 v104, v104
    v_exp_f32 v105, v105
    v_exp_f32 v106, v106
    v_exp_f32 v107, v107
    v_mfma_f32_32x32x16_bf16 v[136:151], v[84:87], v[156:159], v[136:151]
    v_exp_f32 v108, v108
    v_exp_f32 v109, v109
    v_exp_f32 v110, v110
    v_exp_f32 v111, v111
    v_cvt_pk_bf16_f32 v152, v104, v105
    v_cvt_pk_bf16_f32 v153, v106, v107
    v_cvt_pk_bf16_f32 v154, v108, v109
    v_cvt_pk_bf16_f32 v155, v110, v111
    v_exp_f32 v112, v112
    v_exp_f32 v113, v113
    v_mfma_f32_32x32x16_bf16 v[136:151], v[88:91], v[152:155], v[136:151]
    v_exp_f32 v114, v114
    v_exp_f32 v115, v115
    v_exp_f32 v116, v116
    v_exp_f32 v117, v117
    v_exp_f32 v118, v118
    v_exp_f32 v119, v119
    v_cvt_pk_bf16_f32 v156, v112, v113
    v_cvt_pk_bf16_f32 v157, v114, v115
    v_cvt_pk_bf16_f32 v158, v116, v117
    v_cvt_pk_bf16_f32 v159, v118, v119
    v_exp_f32 v120, v120
    v_exp_f32 v121, v121
    v_exp_f32 v122, v122
    v_exp_f32 v123, v123
    v_mfma_f32_32x32x16_bf16 v[136:151], v[92:95], v[156:159], v[136:151]
    v_exp_f32 v124, v124
    v_exp_f32 v125, v125
    v_exp_f32 v126, v126
    v_exp_f32 v127, v127
    v_cvt_pk_bf16_f32 v152, v120, v121
    v_cvt_pk_bf16_f32 v153, v122, v123
    v_cvt_pk_bf16_f32 v154, v124, v125
    v_cvt_pk_bf16_f32 v155, v126, v127
    v_exp_f32 v128, v128
    v_exp_f32 v129, v129
    v_mfma_f32_32x32x16_bf16 v[136:151], v[96:99], v[152:155], v[136:151]
    v_exp_f32 v130, v130
    v_exp_f32 v131, v131
    v_exp_f32 v132, v132
    v_exp_f32 v133, v133
    v_exp_f32 v134, v134
    v_exp_f32 v135, v135
    v_cvt_pk_bf16_f32 v156, v128, v129
    v_cvt_pk_bf16_f32 v157, v130, v131
    v_cvt_pk_bf16_f32 v158, v132, v133
    v_cvt_pk_bf16_f32 v159, v134, v135
    s_nop 0
    s_nop 0
    v_mov_b32 v3, s32
    v_subrev_u32 v164, 16384, v164
    v_mfma_f32_32x32x16_bf16 v[136:151], v[100:103], v[156:159], v[136:151]
    v_writelane_b32 v3, s33, 1
    v_subrev_u32 v165, 2048, v165
    s_mov_b32 s80, 262144
L_fin_rd:
    ds_read_b32 v4, v3
    ds_read_b128 v[104:107], v164
    ds_read_b128 v[108:111], v164 offset:1024
    ds_read_b32 v112, v165
    v_readfirstlane_b32 s72, v2
    v_mov_b32 v118, s34
    s_waitcnt lgkmcnt(0)
    v_cmp_gt_u32 vcc, 8, v4
    s_cbranch_vccz L_fin_go
    s_sleep 1
    s_sub_u32 s80, s80, 1
    s_cmp_lg_u32 s80, 0
    s_cbranch_scc1 L_fin_rd
L_fin_go:
    v_add_f32 v112, v112, v144
    v_writelane_b32 v118, s72, 1
    v_pk_add_f32 v[104:105], v[104:105], v[136:137]
    v_pk_add_f32 v[106:107], v[106:107], v[138:139]
    v_pk_add_f32 v[108:109], v[108:109], v[140:141]
    v_pk_add_f32 v[110:111], v[110:111], v[142:143]
    v_rcp_f32 v114, v112
    v_subrev_u32 v113, 0x30800000, v112
    v_pk_mul_f32 v[116:117], v[104:105], 0
    v_cmp_ge_u32 vcc, 0x2d000000, v113
    v_pk_fma_f32 v[116:117], v[106:107], 0, v[116:117]
    v_pk_fma_f32 v[116:117], v[108:109], 0, v[116:117]
    s_mov_b64 s[76:77], vcc
    v_pk_fma_f32 v[116:117], v[110:111], 0, v[116:117]
    v_cmp_eq_f32 vcc, v116, v117
    s_nop 0
    s_and_b64 s[76:77], s[76:77], vcc
    s_cmp_eq_u64 s[76:77], -1
    s_cbranch_scc0 L_fb
L_norm_fin:
    v_pk_mul_f32 v[104:105], v[104:105], v[114:115] op_sel_hi:[1,0]
    v_pk_mul_f32 v[106:107], v[106:107], v[114:115] op_sel_hi:[1,0]
    v_pk_mul_f32 v[108:109], v[108:109], v[114:115] op_sel_hi:[1,0]
    v_pk_mul_f32 v[110:111], v[110:111], v[114:115] op_sel_hi:[1,0]
    v_cvt_pk_bf16_f32 v120, v104, v105
    v_cvt_pk_bf16_f32 v121, v106, v107
    v_cvt_pk_bf16_f32 v122, v108, v109
    v_cvt_pk_bf16_f32 v123, v110, v111
    v_min_u32 v120, -2, v120
    buffer_store_dwordx4 v[120:123], v1, s[64:67], s35 offen sc1
    s_mov_b64 exec, 3
    ds_add_u32 v118, v167
    s_mov_b64 exec, -1
    s_mov_b32 s82, s3
    s_and_b32 s3, s3, 3
    s_mov_b32 s68, s44
    s_mov_b32 s69, s45
    s_mov_b32 s70, 8388608
    s_mov_b32 s71, 0x20000
    s_setprio 3
    v_mov_b32 v4, 153600
    v_mov_b32 v6, 1
    s_lshl_b32 s77, s3, 1
    s_add_u32 s77, s77, s7
    s_lshl_b32 s78, s7, 16
    s_add_u32 s78, s78, 3145728
    s_lshl_b32 s73, s6, 16
    s_add_u32 s73, s73, 1048576
    s_add_u32 s72, s77, 0
    s_and_b32 s72, s72, 7
    s_lshl_b32 s79, s72, 12
    s_add_u32 s16, s79, s73
    s_add_u32 s22, s16, 32768
    s_lshl_b32 s79, s72, 13
    s_add_u32 s18, s79, s78
    s_add_u32 s19, s18, 4096
    s_add_u32 s72, s77, 1
    s_and_b32 s72, s72, 7
    s_lshl_b32 s79, s72, 12
    s_add_u32 s17, s79, s73
    s_add_u32 s23, s17, 32768
    s_lshl_b32 s79, s72, 13
    s_add_u32 s20, s79, s78
    s_add_u32 s21, s20, 4096
    v_and_b32 v2, 31, v0
    v_lshrrev_b32 v5, 5, v0
    v_xor_b32 v2, v2, v5
    v_lshlrev_b32 v2, 4, v2
    v_lshl_add_u32 v2, v5, 9, v2
    s_lshl_b32 s72, s3, 13
    v_add_u32 v3, s72, v2
    v_and_b32 v2, 15, v0
    v_lshrrev_b32 v5, 4, v0
    s_lshl_b32 s72, s3, 3
    v_add_u32 v5, s72, v5
    v_lshlrev_b32 v0, 4, v2
    v_lshl_add_u32 v0, v5, 12, v0
    v_xor_b32 v5, v5, v2
    v_lshlrev_b32 v5, 4, v5
    v_lshl_add_u32 v7, v2, 9, v5
    s_lshl_b32 s81, s6, 18
    s_lshl_b32 s72, s7, 8
    s_add_u32 s81, s81, s72
    s_add_u32 s24, s81, 2048
    s_add_u32 s25, s81, 18432
    s_add_u32 s26, s81, 133120
    s_add_u32 s27, s81, 149504
    s_cmp_ge_u32 s82, 4
    s_cbranch_scc1 L_hi_fin
    s_mov_b32 s80, 262144
L_lw_9:
    ds_read_b32 v5, v4 offset:16
    s_waitcnt lgkmcnt(0)
    v_readfirstlane_b32 s72, v5
    s_nop 0
    s_cmp_ge_u32 s72, 16
    s_cbranch_scc1 L_lw_ok_10
    s_sleep 1
    s_sub_u32 s80, s80, 1
    s_cmp_lg_u32 s80, 0
    s_cbranch_scc1 L_lw_9
L_lw_ok_10:
    buffer_load_dwordx4 v[8:11], v1, s[64:67], s18 offen offset:0 sc1
    buffer_load_dwordx4 v[12:15], v1, s[64:67], s18 offen offset:1024 sc1
    buffer_load_dwordx4 v[16:19], v1, s[64:67], s18 offen offset:2048 sc1
    buffer_load_dwordx4 v[20:23], v1, s[64:67], s18 offen offset:3072 sc1
    buffer_load_dwordx4 v[24:27], v1, s[64:67], s19 offen offset:0 sc1
    buffer_load_dwordx4 v[28:31], v1, s[64:67], s19 offen offset:1024 sc1
    buffer_load_dwordx4 v[32:35], v1, s[64:67], s19 offen offset:2048 sc1
    buffer_load_dwordx4 v[36:39], v1, s[64:67], s19 offen offset:3072 sc1
    buffer_load_dwordx4 v[40:43], v1, s[64:67], s20 offen offset:0 sc1
    buffer_load_dwordx4 v[44:47], v1, s[64:67], s20 offen offset:1024 sc1
    buffer_load_dwordx4 v[48:51], v1, s[64:67], s20 offen offset:2048 sc1
    buffer_load_dwordx4 v[52:55], v1, s[64:67], s20 offen offset:3072 sc1
    buffer_load_dwordx4 v[56:59], v1, s[64:67], s21 offen offset:0 sc1
    buffer_load_dwordx4 v[60:63], v1, s[64:67], s21 offen offset:1024 sc1
    buffer_load_dwordx4 v[64:67], v1, s[64:67], s21 offen offset:2048 sc1
    buffer_load_dwordx4 v[68:71], v1, s[64:67], s21 offen offset:3072 sc1
    s_mov_b32 s80, 262144
L_lw_11:
    ds_read_b32 v5, v4 offset:28
    s_waitcnt lgkmcnt(0)
    v_readfirstlane_b32 s72, v5
    s_nop 0
    s_cmp_ge_u32 s72, 4
    s_cbranch_scc1 L_lw_ok_12
    s_sleep 1
    s_sub_u32 s80, s80, 1
    s_cmp_lg_u32 s80, 0
    s_cbranch_scc1 L_lw_11
L_lw_ok_12:
    buffer_load_dwordx4 v[72:75], v1, s[64:67], s16 offen offset:0 sc1
    buffer_load_dwordx4 v[76:79], v1, s[64:67], s16 offen offset:1024 sc1
    buffer_load_dwordx4 v[80:83], v1, s[64:67], s16 offen offset:2048 sc1
    buffer_load_dwordx4 v[84:87], v1, s[64:67], s16 offen offset:3072 sc1
    buffer_load_dwordx4 v[88:91], v1, s[64:67], s17 offen offset:0 sc1
    buffer_load_dwordx4 v[92:95], v1, s[64:67], s17 offen offset:1024 sc1
    buffer_load_dwordx4 v[96:99], v1, s[64:67], s17 offen offset:2048 sc1
    buffer_load_dwordx4 v[100:103], v1, s[64:67], s17 offen offset:3072 sc1
    s_waitcnt vmcnt(4)
    v_max3_u32 v2, v72, v76, v80
    v_max_u32 v2, v2, v84
    v_cmp_ne_u32 vcc, -1, v2
    s_nop 0
    s_cmp_eq_u64 vcc, -1
    s_cbranch_scc1 L_og_13
    s_mov_b32 s80, 16384
L_o_14:
    buffer_load_dwordx4 v[72:75], v1, s[64:67], s16 offen offset:0 sc1
    buffer_load_dwordx4 v[76:79], v1, s[64:67], s16 offen offset:1024 sc1
    buffer_load_dwordx4 v[80:83], v1, s[64:67], s16 offen offset:2048 sc1
    buffer_load_dwordx4 v[84:87], v1, s[64:67], s16 offen offset:3072 sc1
    buffer_load_dwordx4 v[88:91], v1, s[64:67], s17 offen offset:0 sc1
    buffer_load_dwordx4 v[92:95], v1, s[64:67], s17 offen offset:1024 sc1
    buffer_load_dwordx4 v[96:99], v1, s[64:67], s17 offen offset:2048 sc1
    buffer_load_dwordx4 v[100:103], v1, s[64:67], s17 offen offset:3072 sc1
    s_waitcnt vmcnt(0)
    v_max3_u32 v2, v72, v76, v80
    v_max_u32 v2, v2, v84
    v_cmp_ne_u32 vcc, -1, v2
    s_nop 0
    s_cmp_eq_u64 vcc, -1
    s_cbranch_scc1 L_o_ok_15
    s_sub_u32 s80, s80, 1
    s_cmp_lg_u32 s80, 0
    s_cbranch_scc1 L_o_14
L_o_ok_15:
L_og_13:
    s_waitcnt vmcnt(0)
    v_max3_u32 v2, v88, v92, v96
    v_max_u32 v2, v2, v100
    v_cmp_ne_u32 vcc, -1, v2
    s_nop 0
    s_cmp_eq_u64 vcc, -1
    s_cbranch_scc1 L_og_16
    s_mov_b32 s80, 16384
L_o_17:
    buffer_load_dwordx4 v[88:91], v1, s[64:67], s17 offen offset:0 sc1
    buffer_load_dwordx4 v[92:95], v1, s[64:67], s17 offen offset:1024 sc1
    buffer_load_dwordx4 v[96:99], v1, s[64:67], s17 offen offset:2048 sc1
    buffer_load_dwordx4 v[100:103], v1, s[64:67], s17 offen offset:3072 sc1
    s_waitcnt vmcnt(0)
    v_max3_u32 v2, v88, v92, v96
    v_max_u32 v2, v2, v100
    v_cmp_ne_u32 vcc, -1, v2
    s_nop 0
    s_cmp_eq_u64 vcc, -1
    s_cbranch_scc1 L_o_ok_18
    s_sub_u32 s80, s80, 1
    s_cmp_lg_u32 s80, 0
    s_cbranch_scc1 L_o_17
L_o_ok_18:
L_og_16:
    v_mfma_f32_32x32x16_bf16 v[104:119], v[8:11], v[72:75], 0
    v_mfma_f32_32x32x16_bf16 v[120:135], v[12:15], v[72:75], 0
    buffer_load_dwordx4 v[136:139], v1, s[64:67], s22 offen offset:0 sc1
    v_mfma_f32_32x32x16_bf16 v[104:119], v[16:19], v[76:79], v[104:119]
    v_mfma_f32_32x32x16_bf16 v[120:135], v[20:23], v[76:79], v[120:135]
    buffer_load_dwordx4 v[140:143], v1, s[64:67], s22 offen offset:1024 sc1
    v_mfma_f32_32x32x16_bf16 v[104:119], v[24:27], v[80:83], v[104:119]
    v_mfma_f32_32x32x16_bf16 v[120:135], v[28:31], v[80:83], v[120:135]
    buffer_load_dwordx4 v[144:147], v1, s[64:67], s22 offen offset:2048 sc1
    v_mfma_f32_32x32x16_bf16 v[104:119], v[32:35], v[84:87], v[104:119]
    v_mfma_f32_32x32x16_bf16 v[120:135], v[36:39], v[84:87], v[120:135]
    buffer_load_dwordx4 v[148:151], v1, s[64:67], s22 offen offset:3072 sc1
    v_mfma_f32_32x32x16_bf16 v[104:119], v[40:43], v[88:91], v[104:119]
    v_mfma_f32_32x32x16_bf16 v[120:135], v[44:47], v[88:91], v[120:135]
    buffer_load_dwordx4 v[152:155], v1, s[64:67], s23 offen offset:0 sc1
    v_mfma_f32_32x32x16_bf16 v[104:119], v[48:51], v[92:95], v[104:119]
    v_mfma_f32_32x32x16_bf16 v[120:135], v[52:55], v[92:95], v[120:135]
    buffer_load_dwordx4 v[156:159], v1, s[64:67], s23 offen offset:1024 sc1
    v_mfma_f32_32x32x16_bf16 v[104:119], v[56:59], v[96:99], v[104:119]
    v_mfma_f32_32x32x16_bf16 v[120:135], v[60:63], v[96:99], v[120:135]
    buffer_load_dwordx4 v[160:163], v1, s[64:67], s23 offen offset:2048 sc1
    v_mfma_f32_32x32x16_bf16 v[104:119], v[64:67], v[100:103], v[104:119]
    v_mfma_f32_32x32x16_bf16 v[120:135], v[68:71], v[100:103], v[120:135]
    buffer_load_dwordx4 v[164:167], v1, s[64:67], s23 offen offset:3072 sc1
    v_add_u32 v3, 65536, v3
    s_waitcnt vmcnt(4)
    v_max3_u32 v2, v136, v140, v144
    v_max_u32 v2, v2, v148
    v_cmp_ne_u32 vcc, -1, v2
    s_nop 0
    s_cmp_eq_u64 vcc, -1
    s_cbranch_scc1 L_og_19
    s_mov_b32 s80, 16384
L_o_20:
    buffer_load_dwordx4 v[136:139], v1, s[64:67], s22 offen offset:0 sc1
    buffer_load_dwordx4 v[140:143], v1, s[64:67], s22 offen offset:1024 sc1
    buffer_load_dwordx4 v[144:147], v1, s[64:67], s22 offen offset:2048 sc1
    buffer_load_dwordx4 v[148:151], v1, s[64:67], s22 offen offset:3072 sc1
    buffer_load_dwordx4 v[152:155], v1, s[64:67], s23 offen offset:0 sc1
    buffer_load_dwordx4 v[156:159], v1, s[64:67], s23 offen offset:1024 sc1
    buffer_load_dwordx4 v[160:163], v1, s[64:67], s23 offen offset:2048 sc1
    buffer_load_dwordx4 v[164:167], v1, s[64:67], s23 offen offset:3072 sc1
    s_waitcnt vmcnt(0)
    v_max3_u32 v2, v136, v140, v144
    v_max_u32 v2, v2, v148
    v_cmp_ne_u32 vcc, -1, v2
    s_nop 0
    s_cmp_eq_u64 vcc, -1
    s_cbranch_scc1 L_o_ok_21
    s_sub_u32 s80, s80, 1
    s_cmp_lg_u32 s80, 0
    s_cbranch_scc1 L_o_20
L_o_ok_21:
L_og_19:
    v_mfma_f32_32x32x16_bf16 v[72:87], v[8:11], v[136:139], 0
    v_mfma_f32_32x32x16_bf16 v[88:103], v[12:15], v[136:139], 0
    v_mfma_f32_32x32x16_bf16 v[72:87], v[16:19], v[140:143], v[72:87]
    v_mfma_f32_32x32x16_bf16 v[88:103], v[20:23], v[140:143], v[88:103]
    v_xor_b32 v5, 0, v3
    ds_write_b128 v5, v[104:107] offset:0
    v_mfma_f32_32x32x16_bf16 v[72:87], v[24:27], v[144:147], v[72:87]
    v_mfma_f32_32x32x16_bf16 v[88:103], v[28:31], v[144:147], v[88:103]
    v_xor_b32 v5, 32, v3
    ds_write_b128 v5, v[108:111] offset:1024
    v_mfma_f32_32x32x16_bf16 v[72:87], v[32:35], v[148:151], v[72:87]
    v_mfma_f32_32x32x16_bf16 v[88:103], v[36:39], v[148:151], v[88:103]
    v_xor_b32 v5, 64, v3
    ds_write_b128 v5, v[112:115] offset:2048
    s_waitcnt vmcnt(0)
    v_max3_u32 v2, v152, v156, v160
    v_max_u32 v2, v2, v164
    v_cmp_ne_u32 vcc, -1, v2
    s_nop 0
    s_cmp_eq_u64 vcc, -1
    s_cbranch_scc1 L_og_22
    s_mov_b32 s80, 16384
L_o_23:
    buffer_load_dwordx4 v[152:155], v1, s[64:67], s23 offen offset:0 sc1
    buffer_load_dwordx4 v[156:159], v1, s[64:67], s23 offen offset:1024 sc1
    buffer_load_dwordx4 v[160:163], v1, s[64:67], s23 offen offset:2048 sc1
    buffer_load_dwordx4 v[164:167], v1, s[64:67], s23 offen offset:3072 sc1
    s_waitcnt vmcnt(0)
    v_max3_u32 v2, v152, v156, v160
    v_max_u32 v2, v2, v164
    v_cmp_ne_u32 vcc, -1, v2
    s_nop 0
    s_cmp_eq_u64 vcc, -1
    s_cbranch_scc1 L_o_ok_24
    s_sub_u32 s80, s80, 1
    s_cmp_lg_u32 s80, 0
    s_cbranch_scc1 L_o_23
L_o_ok_24:
L_og_22:
    v_mfma_f32_32x32x16_bf16 v[72:87], v[40:43], v[152:155], v[72:87]
    v_mfma_f32_32x32x16_bf16 v[88:103], v[44:47], v[152:155], v[88:103]
    v_xor_b32 v5, 96, v3
    ds_write_b128 v5, v[116:119] offset:3072
    v_mfma_f32_32x32x16_bf16 v[72:87], v[48:51], v[156:159], v[72:87]
    v_mfma_f32_32x32x16_bf16 v[88:103], v[52:55], v[156:159], v[88:103]
    v_xor_b32 v5, 128, v3
    ds_write_b128 v5, v[120:123] offset:4096
    v_mfma_f32_32x32x16_bf16 v[72:87], v[56:59], v[160:163], v[72:87]
    v_mfma_f32_32x32x16_bf16 v[88:103], v[60:63], v[160:163], v[88:103]
    v_xor_b32 v5, 160, v3
    ds_write_b128 v5, v[124:127] offset:5120
    v_mfma_f32_32x32x16_bf16 v[72:87], v[64:67], v[164:167], v[72:87]
    v_mfma_f32_32x32x16_bf16 v[88:103], v[68:71], v[164:167], v[88:103]
    v_xor_b32 v5, 192, v3
    ds_write_b128 v5, v[128:131] offset:6144
    v_xor_b32 v5, 224, v3
    ds_write_b128 v5, v[132:135] offset:7168
    s_mov_b64 exec, 1
    ds_add_u32 v4, v6 offset:68
    s_mov_b64 exec, -1
    v_xor_b32 v5, 0, v3
    s_nop 2
    ds_write_b128 v5, v[72:75] offset:49152
    v_xor_b32 v5, 32, v3
    ds_write_b128 v5, v[76:79] offset:50176
    v_xor_b32 v5, 64, v3
    ds_write_b128 v5, v[80:83] offset:51200
    v_xor_b32 v5, 96, v3
    ds_write_b128 v5, v[84:87] offset:52224
    v_xor_b32 v5, 128, v3
    ds_write_b128 v5, v[88:91] offset:53248
    v_xor_b32 v5, 160, v3
    ds_write_b128 v5, v[92:95] offset:54272
    v_xor_b32 v5, 192, v3
    ds_write_b128 v5, v[96:99] offset:55296
    v_xor_b32 v5, 224, v3
    ds_write_b128 v5, v[100:103] offset:56320
    s_mov_b64 exec, 1
    ds_add_u32 v4, v6 offset:72
    s_mov_b64 exec, -1
    v_add_u32 v2, 114688, v7
    v_xor_b32 v3, 64, v2
    s_mov_b32 s80, 262144
L_lw_25:
    ds_read_b32 v5, v4 offset:72
    s_waitcnt lgkmcnt(0)
    v_readfirstlane_b32 s72, v5
    s_nop 0
    s_cmp_ge_u32 s72, 4
    s_cbranch_scc1 L_lw_ok_26
    s_sub_u32 s80, s80, 1
    s_cmp_lg_u32 s80, 0
    s_cbranch_scc1 L_lw_25
L_lw_ok_26:
    ds_read_b128 v[8:11], v2 offset:0
    ds_read_b128 v[12:15], v2 offset:8192
    ds_read_b128 v[16:19], v2 offset:16384
    ds_read_b128 v[20:23], v2 offset:24576
    ds_read_b128 v[24:27], v3 offset:0
    ds_read_b128 v[28:31], v3 offset:8192
    ds_read_b128 v[32:35], v3 offset:16384
    ds_read_b128 v[36:39], v3 offset:24576
    s_waitcnt lgkmcnt(4)
    v_pk_add_f32 v[8:9], v[8:9], v[12:13]
    v_pk_add_f32 v[16:17], v[16:17], v[20:21]
    v_pk_add_f32 v[10:11], v[10:11], v[14:15]
    v_pk_add_f32 v[18:19], v[18:19], v[22:23]
    v_pk_add_f32 v[8:9], v[8:9], v[16:17]
    v_pk_add_f32 v[10:11], v[10:11], v[18:19]
    buffer_store_dwordx4 v[8:11], v0, s[68:71], s26 offen sc1
    s_waitcnt lgkmcnt(0)
    v_pk_add_f32 v[24:25], v[24:25], v[28:29]
    v_pk_add_f32 v[32:33], v[32:33], v[36:37]
    v_pk_add_f32 v[26:27], v[26:27], v[30:31]
    v_pk_add_f32 v[34:35], v[34:35], v[38:39]
    v_pk_add_f32 v[24:25], v[24:25], v[32:33]
    v_pk_add_f32 v[26:27], v[26:27], v[34:35]
    buffer_store_dwordx4 v[24:27], v0, s[68:71], s27 offen sc1
    s_or_b32 s74, s2, s3
    s_cmp_lg_u32 s74, 0
    s_cbranch_scc1 L_A_end
    ds_read_b64 v[2:3], v4
    s_waitcnt lgkmcnt(0)
    s_mov_b64 exec, 1
    buffer_store_dwordx2 v[2:3], v1, s[64:67], 0 offen sc1
    s_mov_b64 exec, -1
    s_branch L_A_end
L_hi_fin:
    v_add_u32 v2, 65536, v7
    v_xor_b32 v3, 64, v2
    s_mov_b32 s80, 262144
L_lw_27:
    ds_read_b32 v5, v4 offset:68
    s_waitcnt lgkmcnt(0)
    v_readfirstlane_b32 s72, v5
    s_nop 0
    s_cmp_ge_u32 s72, 4
    s_cbranch_scc1 L_lw_ok_28
    s_sleep 1
    s_sub_u32 s80, s80, 1
    s_cmp_lg_u32 s80, 0
    s_cbranch_scc1 L_lw_27
L_lw_ok_28:
    ds_read_b128 v[8:11], v2 offset:0
    ds_read_b128 v[12:15], v2 offset:8192
    ds_read_b128 v[16:19], v2 offset:16384
    ds_read_b128 v[20:23], v2 offset:24576
    ds_read_b128 v[24:27], v3 offset:0
    ds_read_b128 v[28:31], v3 offset:8192
    ds_read_b128 v[32:35], v3 offset:16384
    ds_read_b128 v[36:39], v3 offset:24576
    s_waitcnt lgkmcnt(4)
    v_pk_add_f32 v[8:9], v[8:9], v[12:13]
    v_pk_add_f32 v[16:17], v[16:17], v[20:21]
    v_pk_add_f32 v[10:11], v[10:11], v[14:15]
    v_pk_add_f32 v[18:19], v[18:19], v[22:23]
    v_pk_add_f32 v[8:9], v[8:9], v[16:17]
    v_pk_add_f32 v[10:11], v[10:11], v[18:19]
    buffer_store_dwordx4 v[8:11], v0, s[68:71], s24 offen sc1
    s_waitcnt lgkmcnt(0)
    v_pk_add_f32 v[24:25], v[24:25], v[28:29]
    v_pk_add_f32 v[32:33], v[32:33], v[36:37]
    v_pk_add_f32 v[26:27], v[26:27], v[30:31]
    v_pk_add_f32 v[34:35], v[34:35], v[38:39]
    v_pk_add_f32 v[24:25], v[24:25], v[32:33]
    v_pk_add_f32 v[26:27], v[26:27], v[34:35]
    buffer_store_dwordx4 v[24:27], v0, s[68:71], s25 offen sc1
    s_mov_b32 s3, s82
L_A_end:
    s_waitcnt lgkmcnt(0)
L_end:
    s_endpgm
.p2align 6
L_S:
    s_sub_u32 s13, s3, 8
    s_mov_b32 s52, s18
    s_mov_b32 s53, s19
    s_mov_b32 s54, 1024
    s_mov_b32 s55, 0x20000
    s_mov_b32 s56, s20
    s_mov_b32 s57, s21
    s_mov_b32 s58, 1024
    s_mov_b32 s59, 0x20000
    s_mov_b32 s60, s30
    s_mov_b32 s61, s31
    s_mov_b32 s62, 1024
    s_mov_b32 s63, 0x20000
    s_mov_b32 s68, s32
    s_mov_b32 s69, s33
    s_mov_b32 s70, 1024
    s_mov_b32 s71, 0x20000
    v_and_b32 v2, 31, v0
    v_lshlrev_b32 v3, 1, v2
    s_lshl_b32 s74, s9, 6
    s_and_b32 s76, s13, 1
    s_lshl_b32 s77, s7, 1
    s_add_u32 s76, s76, s77
    s_lshl_b32 s77, s76, 6
    s_mov_b32 s76, s74
    v_mov_b32 v22, v3
    v_add_u32 v155, s77, v3
    v_lshrrev_b32 v3, 5, v0
    v_lshlrev_b32 v157, 1, v155
    v_lshl_add_u32 v157, v3, 14, v157
    v_lshl_add_u32 v155, v3, 12, v155
    s_mov_b32 s68, s36
    s_mov_b32 s69, s37
    s_mov_b32 s70, 524288
    s_mov_b32 s71, 0x20000
    v_lshrrev_b32 v2, 3, v0
    v_bfe_u32 v3, v0, 4, 1
    v_lshlrev_b32 v3, 2, v3
    v_and_b32 v7, 7, v0
    v_xor_b32 v3, v3, v7
    v_lshlrev_b32 v3, 4, v3
    v_lshl_add_u32 v159, v2, 10, v3
    s_lshl_b32 s74, s13, 14
    s_lshl_b32 s75, s7, 7
    s_add_u32 s74, s74, s75
    s_lshl_b32 s75, s13, 11
    s_barrier
    s_mov_b32 s72, s50
    s_lshl_b32 s51, s72, 9
    s_add_u32 s51, s51, s74
    s_add_u32 m0, s75, 65536
    s_add_u32 s79, s51, 0
    buffer_load_dwordx4 v159, s[68:71], s79 offen  lds
    s_add_u32 m0, s75, 66560
    s_add_u32 s79, s51, 8192
    buffer_load_dwordx4 v159, s[68:71], s79 offen  lds
    s_add_u32 s72, s72, 128
    s_and_b32 s72, s72, 0x380
    s_lshl_b32 s51, s72, 9
    s_add_u32 s51, s51, s74
    s_add_u32 m0, s75, 73728
    s_add_u32 s79, s51, 0
    buffer_load_dwordx4 v159, s[68:71], s79 offen  lds
    s_add_u32 m0, s75, 74752
    s_add_u32 s79, s51, 8192
    buffer_load_dwordx4 v159, s[68:71], s79 offen  lds
    s_barrier
    s_add_u32 s72, s72, 128
    s_and_b32 s72, s72, 0x380
    s_lshl_b32 s51, s72, 9
    s_add_u32 s51, s51, s74
    s_add_u32 m0, s75, 81920
    s_add_u32 s79, s51, 0
    buffer_load_dwordx4 v159, s[68:71], s79 offen  lds
    s_add_u32 m0, s75, 82944
    s_add_u32 s79, s51, 8192
    buffer_load_dwordx4 v159, s[68:71], s79 offen  lds
    s_add_u32 s72, s72, 128
    s_and_b32 s72, s72, 0x380
    s_lshl_b32 s51, s72, 9
    s_add_u32 s51, s51, s74
    s_add_u32 m0, s75, 90112
    s_add_u32 s79, s51, 0
    buffer_load_dwordx4 v159, s[68:71], s79 offen  lds
    s_add_u32 m0, s75, 91136
    s_add_u32 s79, s51, 8192
    buffer_load_dwordx4 v159, s[68:71], s79 offen  lds
    s_add_u32 s72, s72, 128
    s_and_b32 s72, s72, 0x380
    s_lshl_b32 s51, s72, 9
    s_add_u32 s51, s51, s74
    s_add_u32 m0, s75, 98304
    s_add_u32 s79, s51, 0
    buffer_load_dwordx4 v159, s[68:71], s79 offen  lds
    s_add_u32 m0, s75, 99328
    s_add_u32 s79, s51, 8192
    buffer_load_dwordx4 v159, s[68:71], s79 offen  lds
    s_add_u32 s72, s72, 128
    s_and_b32 s72, s72, 0x380
    s_lshl_b32 s51, s72, 9
    s_add_u32 s51, s51, s74
    s_add_u32 m0, s75, 106496
    s_add_u32 s79, s51, 0
    buffer_load_dwordx4 v159, s[68:71], s79 offen  lds
    s_add_u32 m0, s75, 107520
    s_add_u32 s79, s51, 8192
    buffer_load_dwordx4 v159, s[68:71], s79 offen  lds
    s_add_u32 s72, s72, 128
    s_and_b32 s72, s72, 0x380
    s_lshl_b32 s51, s72, 9
    s_add_u32 s51, s51, s74
    s_add_u32 m0, s75, 114688
    s_add_u32 s79, s51, 0
    buffer_load_dwordx4 v159, s[68:71], s79 offen  lds
    s_add_u32 m0, s75, 115712
    s_add_u32 s79, s51, 8192
    buffer_load_dwordx4 v159, s[68:71], s79 offen  lds
    s_add_u32 s72, s72, 128
    s_and_b32 s72, s72, 0x380
    s_lshl_b32 s51, s72, 9
    s_add_u32 s51, s51, s74
    s_add_u32 m0, s75, 122880
    s_add_u32 s79, s51, 0
    buffer_load_dwordx4 v159, s[68:71], s79 offen  lds
    s_add_u32 m0, s75, 123904
    s_add_u32 s79, s51, 8192
    buffer_load_dwordx4 v159, s[68:71], s79 offen  lds
    s_setprio 3
    s_mov_b32 s68, s32
    s_mov_b32 s69, s33
    s_mov_b32 s70, 1024
    s_mov_b32 s71, 0x20000
    buffer_load_ushort v4, v22, s[52:55], s76 offen
    buffer_load_ushort v5, v22, s[56:59], s76 offen
    buffer_load_ushort v6, v22, s[60:63], s76 offen
    buffer_load_ushort v156, v22, s[68:71], s77 offen
    v_mov_b32 v20, 153600
    v_mov_b32 v21, 1
    s_waitcnt vmcnt(4)
    s_mov_b64 exec, 1
    ds_add_u32 v20, v21 offset:96
    s_mov_b64 exec, -1
    s_waitcnt vmcnt(0)
    v_lshlrev_b32 v4, 16, v4
    v_lshlrev_b32 v5, 16, v5
    v_lshlrev_b32 v6, 16, v6
    v_mul_f32 v6, 0x3fb8aa3b, v6
    v_exp_f32 v6, v6
    s_nop 0
    v_cvt_pk_bf16_f32 v6, v6, v6
    v_lshlrev_b32 v6, 16, v6
    v_mul_f32 v2, v6, v4
    v_mul_f32 v3, v6, v5
    v_mul_f32 v2, 0x3fb8aa3b, v2
    v_mul_f32 v3, 0.15915494, v3
    v_exp_f32 v2, v2
    v_fract_f32 v3, v3
    v_cos_f32 v6, v3
    v_sin_f32 v7, v3
    s_nop 0
    v_mul_f32 v8, v2, v6
    v_mul_f32 v9, v2, v7
    v_fma_f32 v2, v2, v6, -1.0
    v_mul_f32 v3, v4, v4
    v_fma_f32 v3, v5, v5, v3
    v_rcp_f32 v3, v3
    v_mul_f32 v6, v2, v4
    v_fma_f32 v6, v9, v5, v6
    v_mul_f32 v7, v9, v4
    v_fma_f32 v7, -v2, v5, v7
    v_add_f32 v3, v3, v3
    v_mul_f32 v18, v6, v3
    v_mul_f32 v19, v7, v3
    v_mul_f32 v2, v9, v9
    v_add_f32 v3, v8, v8
    v_fma_f32 v4, v8, v8, -v2
    v_mul_f32 v5, v3, v9
    v_mul_f32 v2, v5, v5
    v_add_f32 v3, v4, v4
    v_fma_f32 v6, v4, v4, -v2
    v_mul_f32 v7, v3, v5
    v_mul_f32 v2, v7, v7
    v_add_f32 v3, v6, v6
    v_fma_f32 v10, v6, v6, -v2
    v_mul_f32 v11, v3, v7
    v_mul_f32 v2, v11, v11
    v_add_f32 v3, v10, v10
    v_fma_f32 v12, v10, v10, -v2
    v_mul_f32 v13, v3, v11
    v_mul_f32 v2, v13, v13
    v_add_f32 v3, v12, v12
    v_fma_f32 v4, v12, v12, -v2
    v_mul_f32 v5, v3, v13
    v_mul_f32 v2, v5, v5
    v_add_f32 v3, v4, v4
    v_fma_f32 v6, v4, v4, -v2
    v_mul_f32 v7, v3, v5
    v_mul_f32 v2, v7, v7
    v_add_f32 v3, v6, v6
    v_fma_f32 v14, v6, v6, -v2
    v_mul_f32 v15, v3, v7
    v_cmp_lt_u32 vcc, 31, v0
    v_mov_b32 v2, 1.0
    v_mov_b32 v3, 0
    v_cndmask_b32 v16, v2, v12, vcc
    v_cndmask_b32 v17, v3, v13, vcc
    s_bitcmp0_b32 s13, 0
    s_cbranch_scc1 L_s_w1
    v_mul_f32 v2, v17, v5
    v_mul_f32 v3, v17, v4
    v_fma_f32 v3, v16, v5, v3
    v_fma_f32 v16, v16, v4, -v2
    v_mov_b32 v17, v3
L_s_w1:
    s_bitcmp0_b32 s13, 1
    s_cbranch_scc1 L_s_w2
    v_mul_f32 v2, v17, v7
    v_mul_f32 v3, v17, v6
    v_fma_f32 v3, v16, v7, v3
    v_fma_f32 v16, v16, v6, -v2
    v_mov_b32 v17, v3
L_s_w2:
    v_and_b32 v2, 31, v0
    v_lshrrev_b32 v3, 5, v0
    v_bfe_u32 v4, v0, 2, 1
    v_lshlrev_b32 v4, 4, v4
    v_and_b32 v5, 1, v0
    v_lshl_add_u32 v4, v5, 3, v4
    v_bfe_u32 v5, v0, 1, 1
    v_add_u32 v4, v4, v5
    v_bfe_u32 v5, v0, 3, 2
    v_lshl_add_u32 v4, v5, 1, v4
    v_bfe_u32 v5, v4, 1, 3
    v_xor_b32 v5, v5, v3
    v_lshlrev_b32 v5, 4, v5
    v_lshl_add_u32 v4, v4, 7, v5
    s_mul_i32 s75, s13, 12288
    s_add_u32 s75, s75, 65536
    v_add_u32 v24, s75, v4
    v_bfe_u32 v5, v2, 1, 3
    v_xor_b32 v5, v5, v3
    v_lshlrev_b32 v5, 4, v5
    v_lshl_add_u32 v28, v2, 7, v5
    v_xor_b32 v25, 32, v24
    v_xor_b32 v29, 32, v28
    v_xor_b32 v26, 64, v24
    v_xor_b32 v30, 64, v28
    v_xor_b32 v27, 96, v24
    v_xor_b32 v31, 96, v28
    v_xor_b32 v7, 64, v1
    v_mov_b32 v20, 153600
    v_mov_b32 v21, 1
    v_lshlrev_b32 v6, 4, v0
    v_add_u32 v148, s75, v6
    s_lshl_b32 s74, s13, 9
    s_add_u32 s74, s74, 151552
    v_lshl_add_u32 v149, v0, 3, s74
    v_lshl_add_u32 v151, v2, 3, s74
    v_lshlrev_b32 v150, 3, v2
    v_add_u32 v150, 151552, v150
    v_lshlrev_b32 v152, 4, v2
    s_lshl_b32 s74, s13, 11
    s_add_u32 s76, s74, 98304
    v_lshlrev_b32 v4, 6, v2
    v_lshl_add_u32 v4, v3, 5, v4
    v_add_u32 v153, s76, v4
    v_bfe_u32 v5, v0, 2, 2
    v_lshl_add_u32 v4, v3, 3, v5
    v_lshlrev_b32 v4, 6, v4
    v_bfe_u32 v154, v0, 4, 1
    v_lshl_add_u32 v4, v154, 5, v4
    v_and_b32 v158, 3, v0
    v_lshl_add_u32 v4, v158, 3, v4
    v_lshl_add_u32 v160, v3, 2, v5
    v_lshlrev_b32 v160, 7, v160
    v_bfe_u32 v158, v0, 1, 1
    v_lshl_add_u32 v158, v154, 1, v158
    v_lshrrev_b32 v5, 1, v5
    v_lshl_add_u32 v158, v5, 2, v158
    v_lshl_add_u32 v160, v158, 4, v160
    v_and_b32 v5, 1, v0
    v_lshl_add_u32 v160, v5, 3, v160
    v_add_u32 v154, s76, v4
    v_add_u32 v160, 151552, v160
    s_lshl_b32 s76, s13, 12
    s_add_u32 s76, s76, 0x4000
    v_add_u32 v161, s76, v6
    v_xor_b32 v162, 0x1000, v161
    s_and_b32 s77, s13, 1
    s_lshr_b32 s76, s50, 6
    s_lshl_b32 s78, s77, 3
    s_add_u32 s76, s76, s78
    v_and_b32 v4, 7, v0
    v_add_u32 v4, s76, v4
    v_and_b32 v4, 15, v4
    v_lshlrev_b32 v158, 7, v4
    s_mov_b32 s52, s16
    s_mov_b32 s53, s17
    s_mov_b32 s54, 2097152
    s_mov_b32 s55, 0x20000
    s_cmp_lt_u32 s13, 2
    s_cselect_b32 s56, s22, s24
    s_cselect_b32 s57, s23, s25
    s_mov_b32 s58, 524288
    s_mov_b32 s59, 0x20000
    s_lshl_b32 s74, s8, 2
    s_add_u32 s74, s74, s13
    s_lshl_b32 s74, s74, 15
    s_and_b32 s76, s13, 1
    s_lshl_b32 s77, s9, 1
    s_add_u32 s76, s76, s77
    s_lshl_b32 s76, s76, 14
    s_lshl_b32 s77, s13, 11

    s_setprio 3
    s_mov_b32 s80, 262144
L_lw_29:
    ds_read_b32 v2, v20 offset:64
    s_waitcnt lgkmcnt(0)
    v_readfirstlane_b32 s72, v2
    s_nop 0
    s_cmp_ge_u32 s72, 4
    s_cbranch_scc1 L_lw_ok_30
    s_sleep 1
    s_sub_u32 s80, s80, 1
    s_cmp_lg_u32 s80, 0
    s_cbranch_scc1 L_lw_29
L_lw_ok_30:
    ds_read_b64 v[22:23], v20
    s_mov_b32 s80, 262144
L_lw_31:
    ds_read_b32 v2, v20 offset:20
    s_waitcnt lgkmcnt(0)
    v_readfirstlane_b32 s72, v2
    s_nop 0
    s_cmp_ge_u32 s72, 8
    s_cbranch_scc1 L_lw_ok_32
    s_sleep 1
    s_sub_u32 s80, s80, 1
    s_cmp_lg_u32 s80, 0
    s_cbranch_scc1 L_lw_31
L_lw_ok_32:
    s_mov_b32 s68, s42
    s_mov_b32 s69, s43
    s_mov_b32 s70, 524288
    s_mov_b32 s71, 0x20000
    s_lshl_b32 s78, s6, 14
    s_lshl_b32 s72, s7, 7
    s_add_u32 s78, s78, s72
    s_cmp_lg_u32 s13, 0
    s_cbranch_scc1 L_s_wo1
    s_mov_b32 m0, 151552
    s_add_u32 s79, s78, 0
    buffer_load_dwordx4 v159, s[68:71], s79 offen  lds
    s_mov_b32 m0, 152576
    s_add_u32 s79, s78, 8192
    buffer_load_dwordx4 v159, s[68:71], s79 offen  lds
L_s_wo1:
    s_add_u32 s51, s50, 0
    s_and_b32 s51, s51, 0x380
    s_add_u32 s51, s51, s76
    s_add_u32 m0, s77, 0
    s_add_u32 s79, s51, 0
    buffer_load_dwordx4 v1, s[56:59], s79 offen  lds
    s_add_u32 m0, s77, 1024
    s_add_u32 s79, s51, 8192
    buffer_load_dwordx4 v7, s[56:59], s79 offen  lds
    s_add_u32 s51, s50, 128
    s_and_b32 s51, s51, 0x380
    s_add_u32 s51, s51, s76
    s_add_u32 m0, s77, 8192
    s_add_u32 s79, s51, 0
    buffer_load_dwordx4 v1, s[56:59], s79 offen  lds
    s_add_u32 m0, s77, 9216
    s_add_u32 s79, s51, 8192
    buffer_load_dwordx4 v7, s[56:59], s79 offen  lds
    s_add_u32 s51, s50, 256
    s_and_b32 s51, s51, 0x380
    s_add_u32 s51, s51, s76
    s_add_u32 m0, s77, 16384
    s_add_u32 s79, s51, 0
    buffer_load_dwordx4 v1, s[56:59], s79 offen  lds
    s_add_u32 m0, s77, 17408
    s_add_u32 s79, s51, 8192
    buffer_load_dwordx4 v7, s[56:59], s79 offen  lds
    s_add_u32 s51, s50, 384
    s_and_b32 s51, s51, 0x380
    s_add_u32 s51, s51, s76
    s_add_u32 m0, s77, 24576
    s_add_u32 s79, s51, 0
    buffer_load_dwordx4 v1, s[56:59], s79 offen  lds
    s_add_u32 m0, s77, 25600
    s_add_u32 s79, s51, 8192
    buffer_load_dwordx4 v7, s[56:59], s79 offen  lds
    s_add_u32 s51, s50, 512
    s_and_b32 s51, s51, 0x380
    s_add_u32 s51, s51, s76
    s_add_u32 m0, s77, 32768
    s_add_u32 s79, s51, 0
    buffer_load_dwordx4 v1, s[56:59], s79 offen  lds
    s_add_u32 m0, s77, 33792
    s_add_u32 s79, s51, 8192
    buffer_load_dwordx4 v7, s[56:59], s79 offen  lds
    s_add_u32 s51, s50, 640
    s_and_b32 s51, s51, 0x380
    s_add_u32 s51, s51, s76
    s_add_u32 m0, s77, 40960
    s_add_u32 s79, s51, 0
    buffer_load_dwordx4 v1, s[56:59], s79 offen  lds
    s_add_u32 m0, s77, 41984
    s_add_u32 s79, s51, 8192
    buffer_load_dwordx4 v7, s[56:59], s79 offen  lds
    s_add_u32 s51, s50, 768
    s_and_b32 s51, s51, 0x380
    s_add_u32 s51, s51, s76
    s_add_u32 m0, s77, 49152
    s_add_u32 s79, s51, 0
    buffer_load_dwordx4 v1, s[56:59], s79 offen  lds
    s_add_u32 m0, s77, 50176
    s_add_u32 s79, s51, 8192
    buffer_load_dwordx4 v7, s[56:59], s79 offen  lds
    s_add_u32 s51, s50, 896
    s_and_b32 s51, s51, 0x380
    s_add_u32 s51, s51, s76
    s_add_u32 m0, s77, 57344
    s_add_u32 s79, s51, 0
    buffer_load_dwordx4 v1, s[56:59], s79 offen  lds
    s_add_u32 m0, s77, 58368
    s_add_u32 s79, s51, 8192
    buffer_load_dwordx4 v7, s[56:59], s79 offen  lds
    s_mov_b32 s80, 262144
L_lw_33:
    ds_read_b32 v2, v20 offset:20
    s_waitcnt lgkmcnt(0)
    v_readfirstlane_b32 s72, v2
    s_nop 0
    s_cmp_ge_u32 s72, 8
    s_cbranch_scc1 L_lw_ok_34
    s_sleep 1
    s_sub_u32 s80, s80, 1
    s_cmp_lg_u32 s80, 0
    s_cbranch_scc1 L_lw_33
L_lw_ok_34:
    s_add_u32 s51, s50, 0
    s_and_b32 s51, s51, 0x380
    s_add_u32 s51, s51, s74
    s_add_u32 m0, s75, 0
    s_add_u32 s79, s51, 0
    buffer_load_dwordx4 v1, s[52:55], s79 offen  lds
    s_add_u32 m0, s75, 1024
    s_add_u32 s79, s51, 8192
    buffer_load_dwordx4 v7, s[52:55], s79 offen  lds
    s_add_u32 m0, s75, 2048
    s_add_u32 s79, s51, 16384
    buffer_load_dwordx4 v1, s[52:55], s79 offen  lds
    s_add_u32 m0, s75, 3072
    s_add_u32 s79, s51, 24576
    buffer_load_dwordx4 v7, s[52:55], s79 offen  lds
    s_add_u32 s51, s50, 128
    s_and_b32 s51, s51, 0x380
    s_add_u32 s51, s51, s74
    s_add_u32 m0, s75, 4096
    s_add_u32 s79, s51, 0
    buffer_load_dwordx4 v1, s[52:55], s79 offen  lds
    s_add_u32 m0, s75, 5120
    s_add_u32 s79, s51, 8192
    buffer_load_dwordx4 v7, s[52:55], s79 offen  lds
    s_add_u32 m0, s75, 6144
    s_add_u32 s79, s51, 16384
    buffer_load_dwordx4 v1, s[52:55], s79 offen  lds
    s_add_u32 m0, s75, 7168
    s_add_u32 s79, s51, 24576
    buffer_load_dwordx4 v7, s[52:55], s79 offen  lds
    s_add_u32 s51, s50, 256
    s_and_b32 s51, s51, 0x380
    s_add_u32 s51, s51, s74
    s_add_u32 m0, s75, 8192
    s_add_u32 s79, s51, 0
    buffer_load_dwordx4 v1, s[52:55], s79 offen  lds
    s_add_u32 m0, s75, 9216
    s_add_u32 s79, s51, 8192
    buffer_load_dwordx4 v7, s[52:55], s79 offen  lds
    s_add_u32 m0, s75, 10240
    s_add_u32 s79, s51, 16384
    buffer_load_dwordx4 v1, s[52:55], s79 offen  lds
    s_add_u32 m0, s75, 11264
    s_add_u32 s79, s51, 24576
    buffer_load_dwordx4 v7, s[52:55], s79 offen  lds
    s_waitcnt vmcnt(12)
    s_cmp_lg_u32 s13, 0
    s_cbranch_scc1 L_s_wo2
    v_xor_b32 v2, 64, v160
    ds_read_b64_tr_b16 v[32:33], v160
    ds_read_b64_tr_b16 v[34:35], v160 offset:1024
    ds_read_b64_tr_b16 v[36:37], v2
    ds_read_b64_tr_b16 v[38:39], v2 offset:1024
    s_lshl_b32 s78, s7, 5
    s_add_u32 s78, s78, s6
    s_lshl_b32 s78, s78, 11
    s_add_u32 s78, s78, 3145728
    s_waitcnt vmcnt(0) lgkmcnt(0)
    buffer_store_dwordx4 v[32:35], v6, s[64:67], s78 offen sc1
    buffer_store_dwordx4 v[36:39], v6, s[64:67], s78 offen offset:1024 sc1
    v_mov_b32 v48, -1
    v_mov_b32 v49, -1
    v_mov_b32 v50, -1
    v_mov_b32 v51, -1
    s_lshl_b32 s78, s6, 16
    s_lshl_b32 s72, s7, 12
    s_add_u32 s78, s78, s72
    s_add_u32 s78, s78, 1048576
    s_add_u32 s72, s78, 32768
    buffer_store_dwordx4 v[48:51], v6, s[64:67], s78 offen offset:0 sc1
    buffer_store_dwordx4 v[48:51], v6, s[64:67], s78 offen offset:1024 sc1
    buffer_store_dwordx4 v[48:51], v6, s[64:67], s78 offen offset:2048 sc1
    buffer_store_dwordx4 v[48:51], v6, s[64:67], s78 offen offset:3072 sc1
    buffer_store_dwordx4 v[48:51], v6, s[64:67], s72 offen offset:0 sc1
    buffer_store_dwordx4 v[48:51], v6, s[64:67], s72 offen offset:1024 sc1
    buffer_store_dwordx4 v[48:51], v6, s[64:67], s72 offen offset:2048 sc1
    buffer_store_dwordx4 v[48:51], v6, s[64:67], s72 offen offset:3072 sc1
L_s_wo2:
    s_mov_b64 exec, 1
    ds_add_u32 v20, v21 offset:16
    s_mov_b64 exec, -1
    s_mov_b32 s80, 262144
L_sb_35:
    ds_read_b32 v2, v20 offset:16
    s_waitcnt lgkmcnt(0)
    v_readfirstlane_b32 s72, v2
    s_nop 0
    s_cmp_ge_u32 s72, 4
    s_cbranch_scc1 L_sb_ok_36
    s_sleep 1
    s_sub_u32 s80, s80, 1
    s_cmp_lg_u32 s80, 0
    s_cbranch_scc1 L_sb_35
L_sb_ok_36:
    s_setprio 0
    s_waitcnt vmcnt(8)
    ds_read_b128 v[64:67], v24 offset:0
    ds_read_b128 v[68:71], v28 offset:0
    ds_read_b128 v[72:75], v28 offset:4096
    ds_read_b128 v[76:79], v25 offset:0
    ds_read_b128 v[80:83], v29 offset:0
    ds_read_b128 v[84:87], v29 offset:4096
    ds_read_b128 v[88:91], v26 offset:0
    ds_read_b128 v[92:95], v30 offset:0
    ds_read_b128 v[96:99], v30 offset:4096
    s_add_u32 s51, s50, 384
    s_and_b32 s51, s51, 0x380
    s_add_u32 s51, s51, s74
    s_add_u32 s79, s51, 0
    buffer_load_dwordx4 v[100:103], v1, s[52:55], s79 offen
    s_add_u32 s79, s51, 8192
    buffer_load_dwordx4 v[104:107], v7, s[52:55], s79 offen
    s_add_u32 s79, s51, 16384
    buffer_load_dwordx4 v[108:111], v1, s[52:55], s79 offen
    s_add_u32 s79, s51, 24576
    buffer_load_dwordx4 v[112:115], v7, s[52:55], s79 offen
    s_waitcnt lgkmcnt(6)
    v_mfma_f32_32x32x16_bf16 v[32:47], v[64:67], v[68:71], 0
    v_mfma_f32_32x32x16_bf16 v[48:63], v[64:67], v[72:75], 0
    ds_read_b128 v[64:67], v27 offset:0
    ds_read_b128 v[68:71], v31 offset:0
    ds_read_b128 v[72:75], v31 offset:4096
    s_waitcnt lgkmcnt(6)
    v_mfma_f32_32x32x16_bf16 v[32:47], v[76:79], v[80:83], v[32:47]
    v_mfma_f32_32x32x16_bf16 v[48:63], v[76:79], v[84:87], v[48:63]
    s_waitcnt vmcnt(8)
    ds_read_b128 v[76:79], v24 offset:4096
    ds_read_b128 v[80:83], v28 offset:8192
    ds_read_b128 v[84:87], v28 offset:12288
    s_waitcnt lgkmcnt(6)
    v_mfma_f32_32x32x16_bf16 v[32:47], v[88:91], v[92:95], v[32:47]
    v_mfma_f32_32x32x16_bf16 v[48:63], v[88:91], v[96:99], v[48:63]
    ds_read_b128 v[88:91], v25 offset:4096
    ds_read_b128 v[92:95], v29 offset:8192
    ds_read_b128 v[96:99], v29 offset:12288
    s_waitcnt lgkmcnt(6)
    v_mfma_f32_32x32x16_bf16 v[32:47], v[64:67], v[68:71], v[32:47]
    v_mfma_f32_32x32x16_bf16 v[48:63], v[64:67], v[72:75], v[48:63]
    ds_read_b128 v[64:67], v26 offset:4096
    ds_read_b128 v[68:71], v30 offset:8192
    ds_read_b128 v[72:75], v30 offset:12288
    s_add_u32 s51, s50, 512
    s_and_b32 s51, s51, 0x380
    s_add_u32 s51, s51, s74
    s_add_u32 s79, s51, 0
    buffer_load_dwordx4 v[116:119], v1, s[52:55], s79 offen
    s_add_u32 s79, s51, 8192
    buffer_load_dwordx4 v[120:123], v7, s[52:55], s79 offen
    s_add_u32 s79, s51, 16384
    buffer_load_dwordx4 v[124:127], v1, s[52:55], s79 offen
    s_add_u32 s79, s51, 24576
    buffer_load_dwordx4 v[128:131], v7, s[52:55], s79 offen
    s_waitcnt lgkmcnt(6)
    v_mfma_f32_32x32x16_bf16 v[32:47], v[76:79], v[80:83], v[32:47]
    v_mfma_f32_32x32x16_bf16 v[48:63], v[76:79], v[84:87], v[48:63]
    ds_read_b128 v[76:79], v27 offset:4096
    ds_read_b128 v[80:83], v31 offset:8192
    ds_read_b128 v[84:87], v31 offset:12288
    s_waitcnt lgkmcnt(6)
    v_mfma_f32_32x32x16_bf16 v[32:47], v[88:91], v[92:95], v[32:47]
    v_mfma_f32_32x32x16_bf16 v[48:63], v[88:91], v[96:99], v[48:63]
    s_waitcnt vmcnt(8)
    ds_read_b128 v[88:91], v24 offset:8192
    ds_read_b128 v[92:95], v28 offset:16384
    ds_read_b128 v[96:99], v28 offset:20480
    s_waitcnt lgkmcnt(6)
    v_mfma_f32_32x32x16_bf16 v[32:47], v[64:67], v[68:71], v[32:47]
    v_mfma_f32_32x32x16_bf16 v[48:63], v[64:67], v[72:75], v[48:63]
    ds_read_b128 v[64:67], v25 offset:8192
    ds_read_b128 v[68:71], v29 offset:16384
    ds_read_b128 v[72:75], v29 offset:20480
    s_waitcnt lgkmcnt(6)
    v_mfma_f32_32x32x16_bf16 v[32:47], v[76:79], v[80:83], v[32:47]
    v_mfma_f32_32x32x16_bf16 v[48:63], v[76:79], v[84:87], v[48:63]
    s_waitcnt vmcnt(4)
    ds_write_b128 v148, v[100:103] offset:0
    ds_write_b128 v148, v[104:107] offset:1024
    ds_write_b128 v148, v[108:111] offset:2048
    ds_write_b128 v148, v[112:115] offset:3072
    ds_read_b128 v[76:79], v26 offset:8192
    ds_read_b128 v[80:83], v30 offset:16384
    ds_read_b128 v[84:87], v30 offset:20480
    s_add_u32 s51, s50, 640
    s_and_b32 s51, s51, 0x380
    s_add_u32 s51, s51, s74
    s_add_u32 s79, s51, 0
    buffer_load_dwordx4 v[132:135], v1, s[52:55], s79 offen
    s_add_u32 s79, s51, 8192
    buffer_load_dwordx4 v[136:139], v7, s[52:55], s79 offen
    s_add_u32 s79, s51, 16384
    buffer_load_dwordx4 v[140:143], v1, s[52:55], s79 offen
    s_add_u32 s79, s51, 24576
    buffer_load_dwordx4 v[144:147], v7, s[52:55], s79 offen
    s_waitcnt lgkmcnt(10)
    v_mfma_f32_32x32x16_bf16 v[32:47], v[88:91], v[92:95], v[32:47]
    v_mfma_f32_32x32x16_bf16 v[48:63], v[88:91], v[96:99], v[48:63]
    ds_read_b128 v[88:91], v27 offset:8192
    ds_read_b128 v[92:95], v31 offset:16384
    ds_read_b128 v[96:99], v31 offset:20480
    s_waitcnt lgkmcnt(10)
    v_mfma_f32_32x32x16_bf16 v[32:47], v[64:67], v[68:71], v[32:47]
    v_mfma_f32_32x32x16_bf16 v[48:63], v[64:67], v[72:75], v[48:63]
    ds_read_b128 v[64:67], v24 offset:0
    ds_read_b128 v[68:71], v28 offset:24576
    ds_read_b128 v[72:75], v28 offset:28672
    s_waitcnt lgkmcnt(6)
    v_mfma_f32_32x32x16_bf16 v[32:47], v[76:79], v[80:83], v[32:47]
    v_mfma_f32_32x32x16_bf16 v[48:63], v[76:79], v[84:87], v[48:63]
    ds_read_b128 v[76:79], v25 offset:0
    ds_read_b128 v[80:83], v29 offset:24576
    ds_read_b128 v[84:87], v29 offset:28672
    s_waitcnt lgkmcnt(6)
    v_mfma_f32_32x32x16_bf16 v[32:47], v[88:91], v[92:95], v[32:47]
    v_mfma_f32_32x32x16_bf16 v[48:63], v[88:91], v[96:99], v[48:63]
    s_waitcnt vmcnt(4)
    ds_write_b128 v148, v[116:119] offset:4096
    ds_write_b128 v148, v[120:123] offset:5120
    ds_write_b128 v148, v[124:127] offset:6144
    ds_write_b128 v148, v[128:131] offset:7168
    ds_read_b128 v[88:91], v26 offset:0
    ds_read_b128 v[92:95], v30 offset:24576
    ds_read_b128 v[96:99], v30 offset:28672
    s_add_u32 s51, s50, 768
    s_and_b32 s51, s51, 0x380
    s_add_u32 s51, s51, s74
    s_add_u32 s79, s51, 0
    buffer_load_dwordx4 v[100:103], v1, s[52:55], s79 offen
    s_add_u32 s79, s51, 8192
    buffer_load_dwordx4 v[104:107], v7, s[52:55], s79 offen
    s_add_u32 s79, s51, 16384
    buffer_load_dwordx4 v[108:111], v1, s[52:55], s79 offen
    s_add_u32 s79, s51, 24576
    buffer_load_dwordx4 v[112:115], v7, s[52:55], s79 offen
    s_waitcnt lgkmcnt(10)
    v_mfma_f32_32x32x16_bf16 v[32:47], v[64:67], v[68:71], v[32:47]
    v_mfma_f32_32x32x16_bf16 v[48:63], v[64:67], v[72:75], v[48:63]
    ds_read_b128 v[64:67], v27 offset:0
    ds_read_b128 v[68:71], v31 offset:24576
    ds_read_b128 v[72:75], v31 offset:28672
    s_waitcnt lgkmcnt(10)
    v_mfma_f32_32x32x16_bf16 v[32:47], v[76:79], v[80:83], v[32:47]
    v_mfma_f32_32x32x16_bf16 v[48:63], v[76:79], v[84:87], v[48:63]
    ds_read_b128 v[76:79], v24 offset:4096
    ds_read_b128 v[80:83], v28 offset:32768
    ds_read_b128 v[84:87], v28 offset:36864
    s_waitcnt lgkmcnt(6)
    v_mfma_f32_32x32x16_bf16 v[32:47], v[88:91], v[92:95], v[32:47]
    v_mfma_f32_32x32x16_bf16 v[48:63], v[88:91], v[96:99], v[48:63]
    ds_read_b128 v[88:91], v25 offset:4096
    ds_read_b128 v[92:95], v29 offset:32768
    ds_read_b128 v[96:99], v29 offset:36864
    s_waitcnt lgkmcnt(6)
    v_mfma_f32_32x32x16_bf16 v[32:47], v[64:67], v[68:71], v[32:47]
    v_mfma_f32_32x32x16_bf16 v[48:63], v[64:67], v[72:75], v[48:63]
    s_waitcnt vmcnt(4)
    ds_write_b128 v148, v[132:135] offset:8192
    ds_write_b128 v148, v[136:139] offset:9216
    ds_write_b128 v148, v[140:143] offset:10240
    ds_write_b128 v148, v[144:147] offset:11264
    ds_read_b128 v[64:67], v26 offset:4096
    ds_read_b128 v[68:71], v30 offset:32768
    ds_read_b128 v[72:75], v30 offset:36864
    s_add_u32 s51, s50, 896
    s_and_b32 s51, s51, 0x380
    s_add_u32 s51, s51, s74
    s_add_u32 s79, s51, 0
    buffer_load_dwordx4 v[116:119], v1, s[52:55], s79 offen
    s_add_u32 s79, s51, 8192
    buffer_load_dwordx4 v[120:123], v7, s[52:55], s79 offen
    s_add_u32 s79, s51, 16384
    buffer_load_dwordx4 v[124:127], v1, s[52:55], s79 offen
    s_add_u32 s79, s51, 24576
    buffer_load_dwordx4 v[128:131], v7, s[52:55], s79 offen
    s_waitcnt lgkmcnt(10)
    v_mfma_f32_32x32x16_bf16 v[32:47], v[76:79], v[80:83], v[32:47]
    v_mfma_f32_32x32x16_bf16 v[48:63], v[76:79], v[84:87], v[48:63]
    ds_read_b128 v[76:79], v27 offset:4096
    ds_read_b128 v[80:83], v31 offset:32768
    ds_read_b128 v[84:87], v31 offset:36864
    s_waitcnt lgkmcnt(10)
    v_mfma_f32_32x32x16_bf16 v[32:47], v[88:91], v[92:95], v[32:47]
    v_mfma_f32_32x32x16_bf16 v[48:63], v[88:91], v[96:99], v[48:63]
    ds_read_b128 v[88:91], v24 offset:8192
    ds_read_b128 v[92:95], v28 offset:40960
    ds_read_b128 v[96:99], v28 offset:45056
    s_waitcnt lgkmcnt(6)
    v_mfma_f32_32x32x16_bf16 v[32:47], v[64:67], v[68:71], v[32:47]
    v_mfma_f32_32x32x16_bf16 v[48:63], v[64:67], v[72:75], v[48:63]
    ds_read_b128 v[64:67], v25 offset:8192
    ds_read_b128 v[68:71], v29 offset:40960
    ds_read_b128 v[72:75], v29 offset:45056
    s_waitcnt lgkmcnt(6)
    v_mfma_f32_32x32x16_bf16 v[32:47], v[76:79], v[80:83], v[32:47]
    v_mfma_f32_32x32x16_bf16 v[48:63], v[76:79], v[84:87], v[48:63]
    s_waitcnt vmcnt(4)
    ds_write_b128 v148, v[100:103] offset:0
    ds_write_b128 v148, v[104:107] offset:1024
    ds_write_b128 v148, v[108:111] offset:2048
    ds_write_b128 v148, v[112:115] offset:3072
    ds_read_b128 v[76:79], v26 offset:8192
    ds_read_b128 v[80:83], v30 offset:40960
    ds_read_b128 v[84:87], v30 offset:45056
    s_waitcnt lgkmcnt(10)
    v_mfma_f32_32x32x16_bf16 v[32:47], v[88:91], v[92:95], v[32:47]
    v_mfma_f32_32x32x16_bf16 v[48:63], v[88:91], v[96:99], v[48:63]
    ds_read_b128 v[88:91], v27 offset:8192
    ds_read_b128 v[92:95], v31 offset:40960
    ds_read_b128 v[96:99], v31 offset:45056
    s_waitcnt lgkmcnt(10)
    v_mfma_f32_32x32x16_bf16 v[32:47], v[64:67], v[68:71], v[32:47]
    v_mfma_f32_32x32x16_bf16 v[48:63], v[64:67], v[72:75], v[48:63]
    ds_read_b128 v[64:67], v24 offset:0
    ds_read_b128 v[68:71], v28 offset:49152
    ds_read_b128 v[72:75], v28 offset:53248
    s_waitcnt lgkmcnt(6)
    v_mfma_f32_32x32x16_bf16 v[32:47], v[76:79], v[80:83], v[32:47]
    v_mfma_f32_32x32x16_bf16 v[48:63], v[76:79], v[84:87], v[48:63]
    ds_read_b128 v[76:79], v25 offset:0
    ds_read_b128 v[80:83], v29 offset:49152
    ds_read_b128 v[84:87], v29 offset:53248
    s_waitcnt lgkmcnt(6)
    v_mfma_f32_32x32x16_bf16 v[32:47], v[88:91], v[92:95], v[32:47]
    v_mfma_f32_32x32x16_bf16 v[48:63], v[88:91], v[96:99], v[48:63]
    s_waitcnt vmcnt(0)
    ds_write_b128 v148, v[116:119] offset:4096
    ds_write_b128 v148, v[120:123] offset:5120
    ds_write_b128 v148, v[124:127] offset:6144
    ds_write_b128 v148, v[128:131] offset:7168
    ds_read_b128 v[88:91], v26 offset:0
    ds_read_b128 v[92:95], v30 offset:49152
    ds_read_b128 v[96:99], v30 offset:53248
    s_waitcnt lgkmcnt(10)
    v_mfma_f32_32x32x16_bf16 v[32:47], v[64:67], v[68:71], v[32:47]
    v_mfma_f32_32x32x16_bf16 v[48:63], v[64:67], v[72:75], v[48:63]
    ds_read_b128 v[64:67], v27 offset:0
    ds_read_b128 v[68:71], v31 offset:49152
    ds_read_b128 v[72:75], v31 offset:53248
    s_waitcnt lgkmcnt(10)
    v_mfma_f32_32x32x16_bf16 v[32:47], v[76:79], v[80:83], v[32:47]
    v_mfma_f32_32x32x16_bf16 v[48:63], v[76:79], v[84:87], v[48:63]
    ds_read_b128 v[76:79], v24 offset:4096
    ds_read_b128 v[80:83], v28 offset:57344
    ds_read_b128 v[84:87], v28 offset:61440
    s_waitcnt lgkmcnt(6)
    v_mfma_f32_32x32x16_bf16 v[32:47], v[88:91], v[92:95], v[32:47]
    v_mfma_f32_32x32x16_bf16 v[48:63], v[88:91], v[96:99], v[48:63]
    ds_read_b128 v[88:91], v25 offset:4096
    ds_read_b128 v[92:95], v29 offset:57344
    ds_read_b128 v[96:99], v29 offset:61440
    s_waitcnt lgkmcnt(6)
    v_mfma_f32_32x32x16_bf16 v[32:47], v[64:67], v[68:71], v[32:47]
    v_mfma_f32_32x32x16_bf16 v[48:63], v[64:67], v[72:75], v[48:63]
    ds_read_b128 v[64:67], v26 offset:4096
    ds_read_b128 v[68:71], v30 offset:57344
    ds_read_b128 v[72:75], v30 offset:61440
    s_waitcnt lgkmcnt(6)
    v_mfma_f32_32x32x16_bf16 v[32:47], v[76:79], v[80:83], v[32:47]
    v_mfma_f32_32x32x16_bf16 v[48:63], v[76:79], v[84:87], v[48:63]
    ds_read_b128 v[76:79], v27 offset:4096
    ds_read_b128 v[80:83], v31 offset:57344
    ds_read_b128 v[84:87], v31 offset:61440
    s_waitcnt lgkmcnt(6)
    v_mfma_f32_32x32x16_bf16 v[32:47], v[88:91], v[92:95], v[32:47]
    v_mfma_f32_32x32x16_bf16 v[48:63], v[88:91], v[96:99], v[48:63]
    s_waitcnt lgkmcnt(3)
    v_mfma_f32_32x32x16_bf16 v[32:47], v[64:67], v[68:71], v[32:47]
    v_mfma_f32_32x32x16_bf16 v[48:63], v[64:67], v[72:75], v[48:63]
    s_waitcnt lgkmcnt(0)
    v_mfma_f32_32x32x16_bf16 v[32:47], v[76:79], v[80:83], v[32:47]
    v_mfma_f32_32x32x16_bf16 v[48:63], v[76:79], v[84:87], v[48:63]
    s_cmp_lg_u32 s13, 0
    s_cbranch_scc1 L_s_wo3
    s_lshl_b32 s78, s7, 5
    s_add_u32 s78, s78, s6
    s_lshl_b32 s78, s78, 3
    s_add_u32 s78, s78, 655360
    s_mov_b64 exec, 1
    buffer_store_dwordx2 v[22:23], v6, s[64:67], s78 offen sc1
    s_mov_b64 exec, -1
L_s_wo3:
    s_mov_b32 s56, s26
    s_mov_b32 s57, s27
    s_mov_b32 s58, 524288
    s_mov_b32 s59, 0x20000
    s_mov_b32 s60, s28
    s_mov_b32 s61, s29
    s_mov_b32 s62, 524288
    s_mov_b32 s63, 0x20000
    s_lshl_b32 s82, s7, 2
    s_add_u32 s82, s82, s13
    s_lshl_b32 s82, s82, 14
    s_lshl_b32 s83, s13, 11
    s_lshl_b32 s74, s9, 13
    s_add_u32 s74, s74, 65536
    s_add_u32 s75, s74, 4096
    s_setprio 3
    v_pk_fma_f32 v[68:69], v[8:9], v[32:33], v[34:35] op_sel:[0,0,0] op_sel_hi:[0,1,1]
    v_pk_fma_f32 v[70:71], v[8:9], v[48:49], v[50:51] op_sel:[0,0,0] op_sel_hi:[0,1,1]
    v_pk_fma_f32 v[72:73], v[8:9], v[48:49], v[68:69] op_sel:[1,0,0] op_sel_hi:[1,1,1] neg_lo:[1,0,0] neg_hi:[1,0,0]
    v_pk_fma_f32 v[74:75], v[8:9], v[32:33], v[70:71] op_sel:[1,0,0] op_sel_hi:[1,1,1]
    v_pk_fma_f32 v[68:69], v[8:9], v[72:73], v[36:37] op_sel:[0,0,0] op_sel_hi:[0,1,1]
    v_pk_fma_f32 v[70:71], v[8:9], v[74:75], v[52:53] op_sel:[0,0,0] op_sel_hi:[0,1,1]
    v_pk_fma_f32 v[64:65], v[8:9], v[74:75], v[68:69] op_sel:[1,0,0] op_sel_hi:[1,1,1] neg_lo:[1,0,0] neg_hi:[1,0,0]
    v_pk_fma_f32 v[66:67], v[8:9], v[72:73], v[70:71] op_sel:[1,0,0] op_sel_hi:[1,1,1]
    v_pk_fma_f32 v[68:69], v[8:9], v[64:65], v[38:39] op_sel:[0,0,0] op_sel_hi:[0,1,1]
    v_pk_fma_f32 v[70:71], v[8:9], v[66:67], v[54:55] op_sel:[0,0,0] op_sel_hi:[0,1,1]
    v_pk_fma_f32 v[72:73], v[8:9], v[66:67], v[68:69] op_sel:[1,0,0] op_sel_hi:[1,1,1] neg_lo:[1,0,0] neg_hi:[1,0,0]
    v_pk_fma_f32 v[74:75], v[8:9], v[64:65], v[70:71] op_sel:[1,0,0] op_sel_hi:[1,1,1]
    v_pk_fma_f32 v[68:69], v[8:9], v[72:73], v[40:41] op_sel:[0,0,0] op_sel_hi:[0,1,1]
    v_pk_fma_f32 v[70:71], v[8:9], v[74:75], v[56:57] op_sel:[0,0,0] op_sel_hi:[0,1,1]
    v_pk_fma_f32 v[64:65], v[8:9], v[74:75], v[68:69] op_sel:[1,0,0] op_sel_hi:[1,1,1] neg_lo:[1,0,0] neg_hi:[1,0,0]
    v_pk_fma_f32 v[66:67], v[8:9], v[72:73], v[70:71] op_sel:[1,0,0] op_sel_hi:[1,1,1]
    v_pk_fma_f32 v[68:69], v[8:9], v[64:65], v[42:43] op_sel:[0,0,0] op_sel_hi:[0,1,1]
    v_pk_fma_f32 v[70:71], v[8:9], v[66:67], v[58:59] op_sel:[0,0,0] op_sel_hi:[0,1,1]
    v_pk_fma_f32 v[72:73], v[8:9], v[66:67], v[68:69] op_sel:[1,0,0] op_sel_hi:[1,1,1] neg_lo:[1,0,0] neg_hi:[1,0,0]
    v_pk_fma_f32 v[74:75], v[8:9], v[64:65], v[70:71] op_sel:[1,0,0] op_sel_hi:[1,1,1]
    v_pk_fma_f32 v[68:69], v[8:9], v[72:73], v[44:45] op_sel:[0,0,0] op_sel_hi:[0,1,1]
    v_pk_fma_f32 v[70:71], v[8:9], v[74:75], v[60:61] op_sel:[0,0,0] op_sel_hi:[0,1,1]
    v_pk_fma_f32 v[64:65], v[8:9], v[74:75], v[68:69] op_sel:[1,0,0] op_sel_hi:[1,1,1] neg_lo:[1,0,0] neg_hi:[1,0,0]
    v_pk_fma_f32 v[66:67], v[8:9], v[72:73], v[70:71] op_sel:[1,0,0] op_sel_hi:[1,1,1]
    v_pk_fma_f32 v[68:69], v[8:9], v[64:65], v[46:47] op_sel:[0,0,0] op_sel_hi:[0,1,1]
    v_pk_fma_f32 v[70:71], v[8:9], v[66:67], v[62:63] op_sel:[0,0,0] op_sel_hi:[0,1,1]
    v_pk_fma_f32 v[72:73], v[8:9], v[66:67], v[68:69] op_sel:[1,0,0] op_sel_hi:[1,1,1] neg_lo:[1,0,0] neg_hi:[1,0,0]
    v_pk_fma_f32 v[74:75], v[8:9], v[64:65], v[70:71] op_sel:[1,0,0] op_sel_hi:[1,1,1]
    v_fma_f32 v76, v10, v72, v73
    v_fma_f32 v77, v10, v74, v75
    v_fma_f32 v76, -v11, v74, v76
    v_fma_f32 v77, v11, v72, v77
    ds_write_b64 v149, v[76:77]
    s_waitcnt lgkmcnt(0)
    s_mov_b64 exec, 1
    ds_add_u32 v20, v21 offset:16
    s_mov_b64 exec, -1
    v_mov_b32 v78, 0
    v_mov_b32 v79, 0
    v_cmp_lt_u32 vcc, 31, v0
    s_mov_b32 s80, 262144
L_sb_37:
    ds_read_b32 v5, v20 offset:16
    s_waitcnt lgkmcnt(0)
    v_readfirstlane_b32 s72, v5
    s_nop 0
    s_cmp_ge_u32 s72, 8
    s_cbranch_scc1 L_sb_ok_38
    s_sleep 1
    s_sub_u32 s80, s80, 1
    s_cmp_lg_u32 s80, 0
    s_cbranch_scc1 L_sb_37
L_sb_ok_38:
    ds_read_b64 v[84:85], v150 offset:0
    ds_read_b64 v[86:87], v150 offset:256
    ds_read_b64 v[88:89], v150 offset:512
    ds_read_b64 v[90:91], v150 offset:768
    ds_read_b64 v[92:93], v150 offset:1024
    ds_read_b64 v[94:95], v150 offset:1280
    ds_read_b64 v[96:97], v151
    s_waitcnt lgkmcnt(0)
    s_cmp_le_u32 s13, 0
    s_cbranch_scc1 L_s_pref
    v_pk_fma_f32 v[68:69], v[12:13], v[78:79], v[84:85] op_sel:[0,0,0] op_sel_hi:[0,1,1]
    v_pk_fma_f32 v[78:79], v[12:13], v[78:79], v[68:69] op_sel:[1,1,0] op_sel_hi:[1,0,1] neg_lo:[1,0,0]
    v_pk_fma_f32 v[68:69], v[12:13], v[78:79], v[86:87] op_sel:[0,0,0] op_sel_hi:[0,1,1]
    v_pk_fma_f32 v[78:79], v[12:13], v[78:79], v[68:69] op_sel:[1,1,0] op_sel_hi:[1,0,1] neg_lo:[1,0,0]
    s_cmp_le_u32 s13, 1
    s_cbranch_scc1 L_s_pref
    v_pk_fma_f32 v[68:69], v[12:13], v[78:79], v[88:89] op_sel:[0,0,0] op_sel_hi:[0,1,1]
    v_pk_fma_f32 v[78:79], v[12:13], v[78:79], v[68:69] op_sel:[1,1,0] op_sel_hi:[1,0,1] neg_lo:[1,0,0]
    v_pk_fma_f32 v[68:69], v[12:13], v[78:79], v[90:91] op_sel:[0,0,0] op_sel_hi:[0,1,1]
    v_pk_fma_f32 v[78:79], v[12:13], v[78:79], v[68:69] op_sel:[1,1,0] op_sel_hi:[1,0,1] neg_lo:[1,0,0]
    s_cmp_le_u32 s13, 2
    s_cbranch_scc1 L_s_pref
    v_pk_fma_f32 v[68:69], v[12:13], v[78:79], v[92:93] op_sel:[0,0,0] op_sel_hi:[0,1,1]
    v_pk_fma_f32 v[78:79], v[12:13], v[78:79], v[68:69] op_sel:[1,1,0] op_sel_hi:[1,0,1] neg_lo:[1,0,0]
    v_pk_fma_f32 v[68:69], v[12:13], v[78:79], v[94:95] op_sel:[0,0,0] op_sel_hi:[0,1,1]
    v_pk_fma_f32 v[78:79], v[12:13], v[78:79], v[68:69] op_sel:[1,1,0] op_sel_hi:[1,0,1] neg_lo:[1,0,0]
L_s_pref:
    v_pk_fma_f32 v[68:69], v[12:13], v[78:79], v[96:97] op_sel:[0,0,0] op_sel_hi:[0,1,1]
    v_pk_fma_f32 v[84:85], v[12:13], v[78:79], v[68:69] op_sel:[1,1,0] op_sel_hi:[1,0,1] neg_lo:[1,0,0]
    v_cndmask_b32 v78, v78, v84, vcc
    v_cndmask_b32 v79, v79, v85, vcc
    s_cmp_lg_u32 s13, 3
    s_cbranch_scc1 L_s_nopub
    v_pk_fma_f32 v[68:69], v[12:13], v[78:79], v[76:77] op_sel:[0,0,0] op_sel_hi:[0,1,1]
    v_pk_fma_f32 v[84:85], v[12:13], v[78:79], v[68:69] op_sel:[1,1,0] op_sel_hi:[1,0,1] neg_lo:[1,0,0]
    v_mov_b32 v86, v22
    v_mov_b32 v87, v23
    s_lshl_b32 s76, s8, 9
    s_add_u32 s76, s76, s74
    s_mov_b32 exec_lo, 0
    buffer_store_dwordx4 v[84:87], v152, s[64:67], s76 offen sc1
    s_mov_b32 exec_lo, -1
L_s_nopub:
    s_add_u32 s84, s50, 896
    s_and_b32 s84, s84, 0x380
    s_add_u32 s84, s84, s82
    s_add_u32 s51, s50, 0
    s_and_b32 s51, s51, 0x380
    s_add_u32 s51, s51, s82
    s_add_u32 m0, s83, 0
    s_add_u32 s79, s51, 0
    buffer_load_dwordx4 v1, s[56:59], s79 offen  lds
    s_add_u32 m0, s83, 1024
    s_add_u32 s79, s51, 8192
    buffer_load_dwordx4 v7, s[56:59], s79 offen  lds
    s_add_u32 m0, s83, 8192
    s_add_u32 s79, s51, 0
    buffer_load_dwordx4 v1, s[60:63], s79 offen  lds
    s_add_u32 m0, s83, 9216
    s_add_u32 s79, s51, 8192
    buffer_load_dwordx4 v7, s[60:63], s79 offen  lds
    s_add_u32 s51, s50, 128
    s_and_b32 s51, s51, 0x380
    s_add_u32 s51, s51, s82
    s_add_u32 m0, s83, 16384
    s_add_u32 s79, s51, 0
    buffer_load_dwordx4 v1, s[56:59], s79 offen  lds
    s_add_u32 m0, s83, 17408
    s_add_u32 s79, s51, 8192
    buffer_load_dwordx4 v7, s[56:59], s79 offen  lds
    s_add_u32 m0, s83, 24576
    s_add_u32 s79, s51, 0
    buffer_load_dwordx4 v1, s[60:63], s79 offen  lds
    s_add_u32 m0, s83, 25600
    s_add_u32 s79, s51, 8192
    buffer_load_dwordx4 v7, s[60:63], s79 offen  lds
    s_add_u32 s51, s50, 256
    s_and_b32 s51, s51, 0x380
    s_add_u32 s51, s51, s82
    s_add_u32 m0, s83, 32768
    s_add_u32 s79, s51, 0
    buffer_load_dwordx4 v1, s[56:59], s79 offen  lds
    s_add_u32 m0, s83, 33792
    s_add_u32 s79, s51, 8192
    buffer_load_dwordx4 v7, s[56:59], s79 offen  lds
    s_add_u32 m0, s83, 40960
    s_add_u32 s79, s51, 0
    buffer_load_dwordx4 v1, s[60:63], s79 offen  lds
    s_add_u32 m0, s83, 41984
    s_add_u32 s79, s51, 8192
    buffer_load_dwordx4 v7, s[60:63], s79 offen  lds
    s_add_u32 s51, s50, 384
    s_and_b32 s51, s51, 0x380
    s_add_u32 s51, s51, s82
    s_add_u32 m0, s83, 49152
    s_add_u32 s79, s51, 0
    buffer_load_dwordx4 v1, s[56:59], s79 offen  lds
    s_add_u32 m0, s83, 50176
    s_add_u32 s79, s51, 8192
    buffer_load_dwordx4 v7, s[56:59], s79 offen  lds
    s_add_u32 m0, s83, 57344
    s_add_u32 s79, s51, 0
    buffer_load_dwordx4 v1, s[60:63], s79 offen  lds
    s_add_u32 m0, s83, 58368
    s_add_u32 s79, s51, 8192
    buffer_load_dwordx4 v7, s[60:63], s79 offen  lds
    s_add_u32 s51, s50, 512
    s_and_b32 s51, s51, 0x380
    s_add_u32 s51, s51, s82
    s_add_u32 m0, s83, 65536
    s_add_u32 s79, s51, 0
    buffer_load_dwordx4 v1, s[56:59], s79 offen  lds
    s_add_u32 m0, s83, 66560
    s_add_u32 s79, s51, 8192
    buffer_load_dwordx4 v7, s[56:59], s79 offen  lds
    s_add_u32 m0, s83, 73728
    s_add_u32 s79, s51, 0
    buffer_load_dwordx4 v1, s[60:63], s79 offen  lds
    s_add_u32 m0, s83, 74752
    s_add_u32 s79, s51, 8192
    buffer_load_dwordx4 v7, s[60:63], s79 offen  lds
    s_mov_b32 s80, 16384
L_lb_39:
    s_cmp_le_u32 s8, 0
    s_cbranch_scc1 L_lbl_41
    buffer_load_dwordx4 v[88:91], v152, s[64:67], s74 offen offset:0 sc1
    s_cmp_le_u32 s8, 1
    s_cbranch_scc1 L_lbl_41
    buffer_load_dwordx4 v[92:95], v152, s[64:67], s74 offen offset:512 sc1
    s_cmp_le_u32 s8, 2
    s_cbranch_scc1 L_lbl_41
    buffer_load_dwordx4 v[96:99], v152, s[64:67], s74 offen offset:1024 sc1
    s_cmp_le_u32 s8, 3
    s_cbranch_scc1 L_lbl_41
    buffer_load_dwordx4 v[100:103], v152, s[64:67], s74 offen offset:1536 sc1
    s_cmp_le_u32 s8, 4
    s_cbranch_scc1 L_lbl_41
    buffer_load_dwordx4 v[104:107], v152, s[64:67], s74 offen offset:2048 sc1
    s_cmp_le_u32 s8, 5
    s_cbranch_scc1 L_lbl_41
    buffer_load_dwordx4 v[108:111], v152, s[64:67], s74 offen offset:2560 sc1
    s_cmp_le_u32 s8, 6
    s_cbranch_scc1 L_lbl_41
    buffer_load_dwordx4 v[112:115], v152, s[64:67], s74 offen offset:3072 sc1
    s_cmp_le_u32 s8, 7
    s_cbranch_scc1 L_lbl_41
    buffer_load_dwordx4 v[116:119], v152, s[64:67], s74 offen offset:3584 sc1
    s_cmp_le_u32 s8, 8
    s_cbranch_scc1 L_lbl_41
    buffer_load_dwordx4 v[120:123], v152, s[64:67], s75 offen offset:0 sc1
    s_cmp_le_u32 s8, 9
    s_cbranch_scc1 L_lbl_41
    buffer_load_dwordx4 v[124:127], v152, s[64:67], s75 offen offset:512 sc1
    s_cmp_le_u32 s8, 10
    s_cbranch_scc1 L_lbl_41
    buffer_load_dwordx4 v[128:131], v152, s[64:67], s75 offen offset:1024 sc1
    s_cmp_le_u32 s8, 11
    s_cbranch_scc1 L_lbl_41
    buffer_load_dwordx4 v[132:135], v152, s[64:67], s75 offen offset:1536 sc1
    s_cmp_le_u32 s8, 12
    s_cbranch_scc1 L_lbl_41
    buffer_load_dwordx4 v[136:139], v152, s[64:67], s75 offen offset:2048 sc1
    s_cmp_le_u32 s8, 13
    s_cbranch_scc1 L_lbl_41
    buffer_load_dwordx4 v[140:143], v152, s[64:67], s75 offen offset:2560 sc1
    s_cmp_le_u32 s8, 14
    s_cbranch_scc1 L_lbl_41
    buffer_load_dwordx4 v[144:147], v152, s[64:67], s75 offen offset:3072 sc1
L_lbl_41:
    s_mov_b64 s[76:77], -1
    s_waitcnt vmcnt(0)
    s_cmp_le_u32 s8, 0
    s_cbranch_scc1 L_lbc_42
    v_cmp_eq_u64 vcc, v[90:91], v[22:23]
    s_nop 0
    s_and_b64 s[76:77], s[76:77], vcc
    s_cmp_le_u32 s8, 1
    s_cbranch_scc1 L_lbc_42
    v_cmp_eq_u64 vcc, v[94:95], v[22:23]
    s_nop 0
    s_and_b64 s[76:77], s[76:77], vcc
    s_cmp_le_u32 s8, 2
    s_cbranch_scc1 L_lbc_42
    v_cmp_eq_u64 vcc, v[98:99], v[22:23]
    s_nop 0
    s_and_b64 s[76:77], s[76:77], vcc
    s_cmp_le_u32 s8, 3
    s_cbranch_scc1 L_lbc_42
    v_cmp_eq_u64 vcc, v[102:103], v[22:23]
    s_nop 0
    s_and_b64 s[76:77], s[76:77], vcc
    s_cmp_le_u32 s8, 4
    s_cbranch_scc1 L_lbc_42
    v_cmp_eq_u64 vcc, v[106:107], v[22:23]
    s_nop 0
    s_and_b64 s[76:77], s[76:77], vcc
    s_cmp_le_u32 s8, 5
    s_cbranch_scc1 L_lbc_42
    v_cmp_eq_u64 vcc, v[110:111], v[22:23]
    s_nop 0
    s_and_b64 s[76:77], s[76:77], vcc
    s_cmp_le_u32 s8, 6
    s_cbranch_scc1 L_lbc_42
    v_cmp_eq_u64 vcc, v[114:115], v[22:23]
    s_nop 0
    s_and_b64 s[76:77], s[76:77], vcc
    s_cmp_le_u32 s8, 7
    s_cbranch_scc1 L_lbc_42
    v_cmp_eq_u64 vcc, v[118:119], v[22:23]
    s_nop 0
    s_and_b64 s[76:77], s[76:77], vcc
    s_cmp_le_u32 s8, 8
    s_cbranch_scc1 L_lbc_42
    v_cmp_eq_u64 vcc, v[122:123], v[22:23]
    s_nop 0
    s_and_b64 s[76:77], s[76:77], vcc
    s_cmp_le_u32 s8, 9
    s_cbranch_scc1 L_lbc_42
    v_cmp_eq_u64 vcc, v[126:127], v[22:23]
    s_nop 0
    s_and_b64 s[76:77], s[76:77], vcc
    s_cmp_le_u32 s8, 10
    s_cbranch_scc1 L_lbc_42
    v_cmp_eq_u64 vcc, v[130:131], v[22:23]
    s_nop 0
    s_and_b64 s[76:77], s[76:77], vcc
    s_cmp_le_u32 s8, 11
    s_cbranch_scc1 L_lbc_42
    v_cmp_eq_u64 vcc, v[134:135], v[22:23]
    s_nop 0
    s_and_b64 s[76:77], s[76:77], vcc
    s_cmp_le_u32 s8, 12
    s_cbranch_scc1 L_lbc_42
    v_cmp_eq_u64 vcc, v[138:139], v[22:23]
    s_nop 0
    s_and_b64 s[76:77], s[76:77], vcc
    s_cmp_le_u32 s8, 13
    s_cbranch_scc1 L_lbc_42
    v_cmp_eq_u64 vcc, v[142:143], v[22:23]
    s_nop 0
    s_and_b64 s[76:77], s[76:77], vcc
    s_cmp_le_u32 s8, 14
    s_cbranch_scc1 L_lbc_42
    v_cmp_eq_u64 vcc, v[146:147], v[22:23]
    s_nop 0
    s_and_b64 s[76:77], s[76:77], vcc
L_lbc_42:
    s_cmp_eq_u64 s[76:77], -1
    s_cbranch_scc1 L_lb_ok_40
    s_sleep 4
    s_sub_u32 s80, s80, 1
    s_cmp_lg_u32 s80, 0
    s_cbranch_scc1 L_lb_39
L_lb_ok_40:
    v_mov_b32 v80, 0
    v_mov_b32 v81, 0
    s_cmp_le_u32 s8, 0
    s_cbranch_scc1 L_s_lbd
    v_pk_fma_f32 v[68:69], v[14:15], v[80:81], v[88:89] op_sel:[0,0,0] op_sel_hi:[0,1,1]
    v_pk_fma_f32 v[80:81], v[14:15], v[80:81], v[68:69] op_sel:[1,1,0] op_sel_hi:[1,0,1] neg_lo:[1,0,0]
    s_cmp_le_u32 s8, 1
    s_cbranch_scc1 L_s_lbd
    v_pk_fma_f32 v[68:69], v[14:15], v[80:81], v[92:93] op_sel:[0,0,0] op_sel_hi:[0,1,1]
    v_pk_fma_f32 v[80:81], v[14:15], v[80:81], v[68:69] op_sel:[1,1,0] op_sel_hi:[1,0,1] neg_lo:[1,0,0]
    s_cmp_le_u32 s8, 2
    s_cbranch_scc1 L_s_lbd
    v_pk_fma_f32 v[68:69], v[14:15], v[80:81], v[96:97] op_sel:[0,0,0] op_sel_hi:[0,1,1]
    v_pk_fma_f32 v[80:81], v[14:15], v[80:81], v[68:69] op_sel:[1,1,0] op_sel_hi:[1,0,1] neg_lo:[1,0,0]
    s_cmp_le_u32 s8, 3
    s_cbranch_scc1 L_s_lbd
    v_pk_fma_f32 v[68:69], v[14:15], v[80:81], v[100:101] op_sel:[0,0,0] op_sel_hi:[0,1,1]
    v_pk_fma_f32 v[80:81], v[14:15], v[80:81], v[68:69] op_sel:[1,1,0] op_sel_hi:[1,0,1] neg_lo:[1,0,0]
    s_cmp_le_u32 s8, 4
    s_cbranch_scc1 L_s_lbd
    v_pk_fma_f32 v[68:69], v[14:15], v[80:81], v[104:105] op_sel:[0,0,0] op_sel_hi:[0,1,1]
    v_pk_fma_f32 v[80:81], v[14:15], v[80:81], v[68:69] op_sel:[1,1,0] op_sel_hi:[1,0,1] neg_lo:[1,0,0]
    s_cmp_le_u32 s8, 5
    s_cbranch_scc1 L_s_lbd
    v_pk_fma_f32 v[68:69], v[14:15], v[80:81], v[108:109] op_sel:[0,0,0] op_sel_hi:[0,1,1]
    v_pk_fma_f32 v[80:81], v[14:15], v[80:81], v[68:69] op_sel:[1,1,0] op_sel_hi:[1,0,1] neg_lo:[1,0,0]
    s_cmp_le_u32 s8, 6
    s_cbranch_scc1 L_s_lbd
    v_pk_fma_f32 v[68:69], v[14:15], v[80:81], v[112:113] op_sel:[0,0,0] op_sel_hi:[0,1,1]
    v_pk_fma_f32 v[80:81], v[14:15], v[80:81], v[68:69] op_sel:[1,1,0] op_sel_hi:[1,0,1] neg_lo:[1,0,0]
    s_cmp_le_u32 s8, 7
    s_cbranch_scc1 L_s_lbd
    v_pk_fma_f32 v[68:69], v[14:15], v[80:81], v[116:117] op_sel:[0,0,0] op_sel_hi:[0,1,1]
    v_pk_fma_f32 v[80:81], v[14:15], v[80:81], v[68:69] op_sel:[1,1,0] op_sel_hi:[1,0,1] neg_lo:[1,0,0]
    s_cmp_le_u32 s8, 8
    s_cbranch_scc1 L_s_lbd
    v_pk_fma_f32 v[68:69], v[14:15], v[80:81], v[120:121] op_sel:[0,0,0] op_sel_hi:[0,1,1]
    v_pk_fma_f32 v[80:81], v[14:15], v[80:81], v[68:69] op_sel:[1,1,0] op_sel_hi:[1,0,1] neg_lo:[1,0,0]
    s_cmp_le_u32 s8, 9
    s_cbranch_scc1 L_s_lbd
    v_pk_fma_f32 v[68:69], v[14:15], v[80:81], v[124:125] op_sel:[0,0,0] op_sel_hi:[0,1,1]
    v_pk_fma_f32 v[80:81], v[14:15], v[80:81], v[68:69] op_sel:[1,1,0] op_sel_hi:[1,0,1] neg_lo:[1,0,0]
    s_cmp_le_u32 s8, 10
    s_cbranch_scc1 L_s_lbd
    v_pk_fma_f32 v[68:69], v[14:15], v[80:81], v[128:129] op_sel:[0,0,0] op_sel_hi:[0,1,1]
    v_pk_fma_f32 v[80:81], v[14:15], v[80:81], v[68:69] op_sel:[1,1,0] op_sel_hi:[1,0,1] neg_lo:[1,0,0]
    s_cmp_le_u32 s8, 11
    s_cbranch_scc1 L_s_lbd
    v_pk_fma_f32 v[68:69], v[14:15], v[80:81], v[132:133] op_sel:[0,0,0] op_sel_hi:[0,1,1]
    v_pk_fma_f32 v[80:81], v[14:15], v[80:81], v[68:69] op_sel:[1,1,0] op_sel_hi:[1,0,1] neg_lo:[1,0,0]
    s_cmp_le_u32 s8, 12
    s_cbranch_scc1 L_s_lbd
    v_pk_fma_f32 v[68:69], v[14:15], v[80:81], v[136:137] op_sel:[0,0,0] op_sel_hi:[0,1,1]
    v_pk_fma_f32 v[80:81], v[14:15], v[80:81], v[68:69] op_sel:[1,1,0] op_sel_hi:[1,0,1] neg_lo:[1,0,0]
    s_cmp_le_u32 s8, 13
    s_cbranch_scc1 L_s_lbd
    v_pk_fma_f32 v[68:69], v[14:15], v[80:81], v[140:141] op_sel:[0,0,0] op_sel_hi:[0,1,1]
    v_pk_fma_f32 v[80:81], v[14:15], v[80:81], v[68:69] op_sel:[1,1,0] op_sel_hi:[1,0,1] neg_lo:[1,0,0]
    s_cmp_le_u32 s8, 14
    s_cbranch_scc1 L_s_lbd
    v_pk_fma_f32 v[68:69], v[14:15], v[80:81], v[144:145] op_sel:[0,0,0] op_sel_hi:[0,1,1]
    v_pk_fma_f32 v[80:81], v[14:15], v[80:81], v[68:69] op_sel:[1,1,0] op_sel_hi:[1,0,1] neg_lo:[1,0,0]
L_s_lbd:
    v_fma_f32 v64, v16, v80, v78
    v_fma_f32 v66, v16, v81, v79
    v_fma_f32 v64, -v17, v81, v64
    v_fma_f32 v66, v17, v80, v66
    v_fma_f32 v65, v10, v64, v72
    v_fma_f32 v67, v10, v66, v74
    v_fma_f32 v65, -v11, v66, v65
    v_fma_f32 v67, v11, v64, v67
    v_pk_fma_f32 v[32:33], v[8:9], v[64:65], v[32:33] op_sel:[0,0,0] op_sel_hi:[0,1,1]
    v_pk_fma_f32 v[48:49], v[8:9], v[66:67], v[48:49] op_sel:[0,0,0] op_sel_hi:[0,1,1]
    v_pk_fma_f32 v[32:33], v[8:9], v[66:67], v[32:33] op_sel:[1,0,0] op_sel_hi:[1,1,1] neg_lo:[1,0,0] neg_hi:[1,0,0]
    v_pk_fma_f32 v[48:49], v[8:9], v[64:65], v[48:49] op_sel:[1,0,0] op_sel_hi:[1,1,1]
    v_pk_fma_f32 v[34:35], v[8:9], v[32:33], v[34:35] op_sel:[0,0,0] op_sel_hi:[0,1,1]
    v_pk_fma_f32 v[50:51], v[8:9], v[48:49], v[50:51] op_sel:[0,0,0] op_sel_hi:[0,1,1]
    v_pk_fma_f32 v[34:35], v[8:9], v[48:49], v[34:35] op_sel:[1,0,0] op_sel_hi:[1,1,1] neg_lo:[1,0,0] neg_hi:[1,0,0]
    v_pk_fma_f32 v[50:51], v[8:9], v[32:33], v[50:51] op_sel:[1,0,0] op_sel_hi:[1,1,1]
    v_pk_fma_f32 v[36:37], v[8:9], v[34:35], v[36:37] op_sel:[0,0,0] op_sel_hi:[0,1,1]
    v_pk_fma_f32 v[52:53], v[8:9], v[50:51], v[52:53] op_sel:[0,0,0] op_sel_hi:[0,1,1]
    v_pk_fma_f32 v[36:37], v[8:9], v[50:51], v[36:37] op_sel:[1,0,0] op_sel_hi:[1,1,1] neg_lo:[1,0,0] neg_hi:[1,0,0]
    v_pk_fma_f32 v[52:53], v[8:9], v[34:35], v[52:53] op_sel:[1,0,0] op_sel_hi:[1,1,1]
    v_pk_fma_f32 v[38:39], v[8:9], v[36:37], v[38:39] op_sel:[0,0,0] op_sel_hi:[0,1,1]
    v_pk_fma_f32 v[54:55], v[8:9], v[52:53], v[54:55] op_sel:[0,0,0] op_sel_hi:[0,1,1]
    v_pk_fma_f32 v[38:39], v[8:9], v[52:53], v[38:39] op_sel:[1,0,0] op_sel_hi:[1,1,1] neg_lo:[1,0,0] neg_hi:[1,0,0]
    v_pk_fma_f32 v[54:55], v[8:9], v[36:37], v[54:55] op_sel:[1,0,0] op_sel_hi:[1,1,1]
    v_pk_fma_f32 v[40:41], v[8:9], v[38:39], v[40:41] op_sel:[0,0,0] op_sel_hi:[0,1,1]
    v_pk_fma_f32 v[56:57], v[8:9], v[54:55], v[56:57] op_sel:[0,0,0] op_sel_hi:[0,1,1]
    v_pk_fma_f32 v[40:41], v[8:9], v[54:55], v[40:41] op_sel:[1,0,0] op_sel_hi:[1,1,1] neg_lo:[1,0,0] neg_hi:[1,0,0]
    v_pk_fma_f32 v[56:57], v[8:9], v[38:39], v[56:57] op_sel:[1,0,0] op_sel_hi:[1,1,1]
    v_pk_fma_f32 v[42:43], v[8:9], v[40:41], v[42:43] op_sel:[0,0,0] op_sel_hi:[0,1,1]
    v_pk_fma_f32 v[58:59], v[8:9], v[56:57], v[58:59] op_sel:[0,0,0] op_sel_hi:[0,1,1]
    v_pk_fma_f32 v[42:43], v[8:9], v[56:57], v[42:43] op_sel:[1,0,0] op_sel_hi:[1,1,1] neg_lo:[1,0,0] neg_hi:[1,0,0]
    v_pk_fma_f32 v[58:59], v[8:9], v[40:41], v[58:59] op_sel:[1,0,0] op_sel_hi:[1,1,1]
    v_pk_fma_f32 v[44:45], v[8:9], v[42:43], v[44:45] op_sel:[0,0,0] op_sel_hi:[0,1,1]
    v_pk_fma_f32 v[60:61], v[8:9], v[58:59], v[60:61] op_sel:[0,0,0] op_sel_hi:[0,1,1]
    v_pk_fma_f32 v[44:45], v[8:9], v[58:59], v[44:45] op_sel:[1,0,0] op_sel_hi:[1,1,1] neg_lo:[1,0,0] neg_hi:[1,0,0]
    v_pk_fma_f32 v[60:61], v[8:9], v[42:43], v[60:61] op_sel:[1,0,0] op_sel_hi:[1,1,1]
    v_pk_fma_f32 v[46:47], v[8:9], v[44:45], v[46:47] op_sel:[0,0,0] op_sel_hi:[0,1,1]
    v_pk_fma_f32 v[62:63], v[8:9], v[60:61], v[62:63] op_sel:[0,0,0] op_sel_hi:[0,1,1]
    v_pk_fma_f32 v[46:47], v[8:9], v[60:61], v[46:47] op_sel:[1,0,0] op_sel_hi:[1,1,1] neg_lo:[1,0,0] neg_hi:[1,0,0]
    v_pk_fma_f32 v[62:63], v[8:9], v[44:45], v[62:63] op_sel:[1,0,0] op_sel_hi:[1,1,1]
    v_pk_mul_f32 v[64:65], v[18:19], v[32:33] op_sel:[0,0] op_sel_hi:[0,1]
    v_pk_mul_f32 v[80:81], v[18:19], v[48:49] op_sel:[0,0] op_sel_hi:[0,1] neg_lo:[1,0] neg_hi:[1,0]
    v_pk_fma_f32 v[64:65], v[18:19], v[48:49], v[64:65] op_sel:[1,0,0] op_sel_hi:[1,1,1] neg_lo:[1,0,0] neg_hi:[1,0,0]
    v_pk_fma_f32 v[80:81], v[18:19], v[32:33], v[80:81] op_sel:[1,0,0] op_sel_hi:[1,1,1] neg_lo:[1,0,0] neg_hi:[1,0,0]
    v_pk_mul_f32 v[66:67], v[18:19], v[34:35] op_sel:[0,0] op_sel_hi:[0,1]
    v_pk_mul_f32 v[82:83], v[18:19], v[50:51] op_sel:[0,0] op_sel_hi:[0,1] neg_lo:[1,0] neg_hi:[1,0]
    v_pk_fma_f32 v[66:67], v[18:19], v[50:51], v[66:67] op_sel:[1,0,0] op_sel_hi:[1,1,1] neg_lo:[1,0,0] neg_hi:[1,0,0]
    v_pk_fma_f32 v[82:83], v[18:19], v[34:35], v[82:83] op_sel:[1,0,0] op_sel_hi:[1,1,1] neg_lo:[1,0,0] neg_hi:[1,0,0]
    v_pk_mul_f32 v[68:69], v[18:19], v[36:37] op_sel:[0,0] op_sel_hi:[0,1]
    v_pk_mul_f32 v[84:85], v[18:19], v[52:53] op_sel:[0,0] op_sel_hi:[0,1] neg_lo:[1,0] neg_hi:[1,0]
    v_pk_fma_f32 v[68:69], v[18:19], v[52:53], v[68:69] op_sel:[1,0,0] op_sel_hi:[1,1,1] neg_lo:[1,0,0] neg_hi:[1,0,0]
    v_pk_fma_f32 v[84:85], v[18:19], v[36:37], v[84:85] op_sel:[1,0,0] op_sel_hi:[1,1,1] neg_lo:[1,0,0] neg_hi:[1,0,0]
    v_pk_mul_f32 v[70:71], v[18:19], v[38:39] op_sel:[0,0] op_sel_hi:[0,1]
    v_pk_mul_f32 v[86:87], v[18:19], v[54:55] op_sel:[0,0] op_sel_hi:[0,1] neg_lo:[1,0] neg_hi:[1,0]
    v_pk_fma_f32 v[70:71], v[18:19], v[54:55], v[70:71] op_sel:[1,0,0] op_sel_hi:[1,1,1] neg_lo:[1,0,0] neg_hi:[1,0,0]
    v_pk_fma_f32 v[86:87], v[18:19], v[38:39], v[86:87] op_sel:[1,0,0] op_sel_hi:[1,1,1] neg_lo:[1,0,0] neg_hi:[1,0,0]
    v_pk_mul_f32 v[72:73], v[18:19], v[40:41] op_sel:[0,0] op_sel_hi:[0,1]
    v_pk_mul_f32 v[88:89], v[18:19], v[56:57] op_sel:[0,0] op_sel_hi:[0,1] neg_lo:[1,0] neg_hi:[1,0]
    v_pk_fma_f32 v[72:73], v[18:19], v[56:57], v[72:73] op_sel:[1,0,0] op_sel_hi:[1,1,1] neg_lo:[1,0,0] neg_hi:[1,0,0]
    v_pk_fma_f32 v[88:89], v[18:19], v[40:41], v[88:89] op_sel:[1,0,0] op_sel_hi:[1,1,1] neg_lo:[1,0,0] neg_hi:[1,0,0]
    v_pk_mul_f32 v[74:75], v[18:19], v[42:43] op_sel:[0,0] op_sel_hi:[0,1]
    v_pk_mul_f32 v[90:91], v[18:19], v[58:59] op_sel:[0,0] op_sel_hi:[0,1] neg_lo:[1,0] neg_hi:[1,0]
    v_pk_fma_f32 v[74:75], v[18:19], v[58:59], v[74:75] op_sel:[1,0,0] op_sel_hi:[1,1,1] neg_lo:[1,0,0] neg_hi:[1,0,0]
    v_pk_fma_f32 v[90:91], v[18:19], v[42:43], v[90:91] op_sel:[1,0,0] op_sel_hi:[1,1,1] neg_lo:[1,0,0] neg_hi:[1,0,0]
    v_pk_mul_f32 v[76:77], v[18:19], v[44:45] op_sel:[0,0] op_sel_hi:[0,1]
    v_pk_mul_f32 v[92:93], v[18:19], v[60:61] op_sel:[0,0] op_sel_hi:[0,1] neg_lo:[1,0] neg_hi:[1,0]
    v_pk_fma_f32 v[76:77], v[18:19], v[60:61], v[76:77] op_sel:[1,0,0] op_sel_hi:[1,1,1] neg_lo:[1,0,0] neg_hi:[1,0,0]
    v_pk_fma_f32 v[92:93], v[18:19], v[44:45], v[92:93] op_sel:[1,0,0] op_sel_hi:[1,1,1] neg_lo:[1,0,0] neg_hi:[1,0,0]
    v_pk_mul_f32 v[78:79], v[18:19], v[46:47] op_sel:[0,0] op_sel_hi:[0,1]
    v_pk_mul_f32 v[94:95], v[18:19], v[62:63] op_sel:[0,0] op_sel_hi:[0,1] neg_lo:[1,0] neg_hi:[1,0]
    v_pk_fma_f32 v[78:79], v[18:19], v[62:63], v[78:79] op_sel:[1,0,0] op_sel_hi:[1,1,1] neg_lo:[1,0,0] neg_hi:[1,0,0]
    v_pk_fma_f32 v[94:95], v[18:19], v[46:47], v[94:95] op_sel:[1,0,0] op_sel_hi:[1,1,1] neg_lo:[1,0,0] neg_hi:[1,0,0]
    v_cvt_pk_bf16_f32 v100, v64, v66
    v_cvt_pk_bf16_f32 v101, v68, v70
    v_cvt_pk_bf16_f32 v102, v72, v74
    v_cvt_pk_bf16_f32 v103, v76, v78
    ds_write_b128 v153, v[100:103] offset:0
    v_cvt_pk_bf16_f32 v104, v65, v67
    v_cvt_pk_bf16_f32 v105, v69, v71
    v_cvt_pk_bf16_f32 v106, v73, v75
    v_cvt_pk_bf16_f32 v107, v77, v79
    ds_write_b128 v153, v[104:107] offset:16
    v_cvt_pk_bf16_f32 v108, v80, v82
    v_cvt_pk_bf16_f32 v109, v84, v86
    v_cvt_pk_bf16_f32 v110, v88, v90
    v_cvt_pk_bf16_f32 v111, v92, v94
    ds_write_b128 v153, v[108:111] offset:8192
    v_cvt_pk_bf16_f32 v112, v81, v83
    v_cvt_pk_bf16_f32 v113, v85, v87
    v_cvt_pk_bf16_f32 v114, v89, v91
    v_cvt_pk_bf16_f32 v115, v93, v95
    ds_write_b128 v153, v[112:115] offset:8208
    ds_read_b64_tr_b16 v[116:117], v154 offset:0
    ds_read_b64_tr_b16 v[118:119], v154 offset:256
    ds_read_b64_tr_b16 v[120:121], v154 offset:1024
    ds_read_b64_tr_b16 v[122:123], v154 offset:1280
    ds_read_b64_tr_b16 v[124:125], v154 offset:8192
    ds_read_b64_tr_b16 v[126:127], v154 offset:8448
    ds_read_b64_tr_b16 v[128:129], v154 offset:9216
    ds_read_b64_tr_b16 v[130:131], v154 offset:9472
    s_lshl_b32 s75, s8, 2
    s_add_u32 s75, s75, s13
    s_lshl_b32 s76, s75, 16
    s_lshl_b32 s77, s9, 12
    s_add_u32 s76, s76, s77
    s_add_u32 s76, s76, 4194304
    s_lshl_b32 s75, s75, 4
    s_add_u32 s75, s75, s9
    s_lshl_b32 s75, s75, 7
    s_add_u32 s75, s75, 524288
    s_waitcnt lgkmcnt(0)
    buffer_store_dwordx4 v[116:119], v6, s[64:67], s76 offen offset:0 sc1
    buffer_store_dwordx4 v[120:123], v6, s[64:67], s76 offen offset:1024 sc1
    buffer_store_dwordx4 v[124:127], v6, s[64:67], s76 offen offset:2048 sc1
    buffer_store_dwordx4 v[128:131], v6, s[64:67], s76 offen offset:3072 sc1
    s_and_b32 s76, s13, 1
    s_lshl_b32 s77, s76, 16
    s_cmp_eq_u32 s76, 0
    s_cselect_b32 s78, 49152, 0
    s_lshl_b32 s72, s76, 12
    s_add_u32 s77, s77, s72
    s_add_u32 s78, s78, s72
    v_add_u32 v24, s77, v28
    v_add_u32 v28, s78, v28
    v_add_u32 v25, s77, v29
    v_add_u32 v29, s78, v29
    v_add_u32 v26, s77, v30
    v_add_u32 v30, s78, v30
    v_add_u32 v27, s77, v31
    v_add_u32 v31, s78, v31
    v_xor_b32 v12, 0x1000, v24
    v_xor_b32 v16, 0x1000, v28
    v_xor_b32 v13, 0x1000, v25
    v_xor_b32 v17, 0x1000, v29
    v_xor_b32 v14, 0x1000, v26
    v_xor_b32 v18, 0x1000, v30
    v_xor_b32 v15, 0x1000, v27
    v_xor_b32 v19, 0x1000, v31
    s_lshr_b32 s77, s13, 1
    s_lshl_b32 s78, s6, 1
    s_add_u32 s81, s77, s78
    s_waitcnt vmcnt(0)
    s_mov_b64 exec, 1
    buffer_store_dwordx2 v[22:23], v6, s[64:67], s75 offen sc1
    s_mov_b64 exec, -1
    s_add_u32 s51, s50, 640
    s_and_b32 s51, s51, 0x380
    s_add_u32 s51, s51, s82
    s_add_u32 m0, s83, 81920
    s_add_u32 s79, s51, 0
    buffer_load_dwordx4 v1, s[56:59], s79 offen  lds
    s_add_u32 m0, s83, 82944
    s_add_u32 s79, s51, 8192
    buffer_load_dwordx4 v7, s[56:59], s79 offen  lds
    s_add_u32 m0, s83, 90112
    s_add_u32 s79, s51, 0
    buffer_load_dwordx4 v1, s[60:63], s79 offen  lds
    s_add_u32 m0, s83, 91136
    s_add_u32 s79, s51, 8192
    buffer_load_dwordx4 v7, s[60:63], s79 offen  lds
    s_add_u32 s51, s50, 768
    s_and_b32 s51, s51, 0x380
    s_add_u32 s51, s51, s82
    s_add_u32 m0, s83, 98304
    s_add_u32 s79, s51, 0
    buffer_load_dwordx4 v1, s[56:59], s79 offen  lds
    s_add_u32 m0, s83, 99328
    s_add_u32 s79, s51, 8192
    buffer_load_dwordx4 v7, s[56:59], s79 offen  lds
    s_add_u32 m0, s83, 106496
    s_add_u32 s79, s51, 0
    buffer_load_dwordx4 v1, s[60:63], s79 offen  lds
    s_add_u32 m0, s83, 107520
    s_add_u32 s79, s51, 8192
    buffer_load_dwordx4 v7, s[60:63], s79 offen  lds
    s_lshl_b32 s76, s76, 9
    s_add_u32 s50, s50, s76
    v_mov_b32 v8, v155
    v_mov_b32 v9, v156
    v_mov_b32 v10, v157
    v_mov_b32 v11, v161
    v_mov_b32 v4, v162
    s_lshl_b32 s74, s81, 11
    s_add_u32 s74, s74, 524288
    s_lshl_b32 s75, s7, 8
    s_add_u32 s75, s75, 655360
    s_sub_u32 s75, s75, s74
    s_mov_b32 exec_lo, 0
    v_lshrrev_b32 v158, 1, v152
    v_add_u32 v158, s75, v158
    s_mov_b64 exec, 0xff00
    s_lshl_b32 s75, s6, 3
    s_add_u32 s75, s75, 653312
    s_sub_u32 s75, s75, s74
    v_lshl_add_u32 v158, v0, 8, s75
    s_mov_b64 exec, -1
    s_lshl_b32 s75, s81, 16
    s_add_u32 s75, s75, 4194304
    s_waitcnt vmcnt(0)
    s_mov_b32 s80, 16384
L_hf_43:
    buffer_load_dwordx2 v[2:3], v158, s[64:67], s74 offen sc1
    s_waitcnt vmcnt(0)
    v_cmp_eq_u64 vcc, v[2:3], v[22:23]
    s_nop 0
    s_cmp_eq_u64 vcc, -1
    s_cbranch_scc1 L_hf_ok_44
    s_sleep 4
    s_sub_u32 s80, s80, 1
    s_cmp_lg_u32 s80, 0
    s_cbranch_scc1 L_hf_43
L_hf_ok_44:
    s_mov_b64 exec, 1
    ds_add_u32 v20, v21 offset:16
    s_mov_b64 exec, -1
    s_add_u32 s76, s50, 0
    s_and_b32 s76, s76, 0x380
    s_lshl_b32 s76, s76, 6
    s_add_u32 s76, s76, s75
    buffer_load_dwordx4 v[88:91], v6, s[64:67], s76 offen offset:0 sc1
    buffer_load_dwordx4 v[92:95], v6, s[64:67], s76 offen offset:1024 sc1
    buffer_load_dwordx4 v[96:99], v6, s[64:67], s76 offen offset:2048 sc1
    buffer_load_dwordx4 v[100:103], v6, s[64:67], s76 offen offset:3072 sc1
    s_add_u32 s76, s76, 4096
    buffer_load_dwordx4 v[104:107], v6, s[64:67], s76 offen offset:0 sc1
    buffer_load_dwordx4 v[108:111], v6, s[64:67], s76 offen offset:1024 sc1
    buffer_load_dwordx4 v[112:115], v6, s[64:67], s76 offen offset:2048 sc1
    buffer_load_dwordx4 v[116:119], v6, s[64:67], s76 offen offset:3072 sc1
    s_add_u32 s76, s50, 128
    s_and_b32 s76, s76, 0x380
    s_lshl_b32 s76, s76, 6
    s_add_u32 s76, s76, s75
    buffer_load_dwordx4 v[120:123], v6, s[64:67], s76 offen offset:0 sc1
    buffer_load_dwordx4 v[124:127], v6, s[64:67], s76 offen offset:1024 sc1
    buffer_load_dwordx4 v[128:131], v6, s[64:67], s76 offen offset:2048 sc1
    buffer_load_dwordx4 v[132:135], v6, s[64:67], s76 offen offset:3072 sc1
    s_add_u32 s76, s76, 4096
    buffer_load_dwordx4 v[136:139], v6, s[64:67], s76 offen offset:0 sc1
    buffer_load_dwordx4 v[140:143], v6, s[64:67], s76 offen offset:1024 sc1
    buffer_load_dwordx4 v[144:147], v6, s[64:67], s76 offen offset:2048 sc1
    buffer_load_dwordx4 v[148:151], v6, s[64:67], s76 offen offset:3072 sc1
    s_mov_b32 s80, 262144
L_sb_45:
    ds_read_b32 v5, v20 offset:16
    s_waitcnt lgkmcnt(0)
    v_readfirstlane_b32 s72, v5
    s_nop 0
    s_cmp_ge_u32 s72, 12
    s_cbranch_scc1 L_sb_ok_46
    s_sleep 1
    s_sub_u32 s80, s80, 1
    s_cmp_lg_u32 s80, 0
    s_cbranch_scc1 L_sb_45
L_sb_ok_46:
    s_lshl_b32 s77, s13, 2
    v_add_u32 v2, s77, v20
    s_setprio 0
    ds_read_b128 v[64:67], v24 offset:0
    ds_read_b128 v[68:71], v12 offset:0
    ds_read_b128 v[72:75], v25 offset:0
    ds_read_b128 v[76:79], v13 offset:0
    ds_read_b128 v[80:83], v24 offset:8192
    ds_read_b128 v[84:87], v12 offset:8192
    s_waitcnt vmcnt(15) lgkmcnt(4)
    v_mfma_f32_32x32x16_bf16 v[32:47], v[88:91], v[64:67], 0
    v_mfma_f32_32x32x16_bf16 v[48:63], v[88:91], v[68:71], 0
    s_add_u32 s76, s50, 256
    s_and_b32 s76, s76, 0x380
    s_lshl_b32 s76, s76, 6
    s_add_u32 s76, s76, s75
    buffer_load_dwordx4 v[88:91], v6, s[64:67], s76 offen offset:0 sc1
    ds_read_b128 v[64:67], v25 offset:8192
    ds_read_b128 v[68:71], v13 offset:8192
    s_waitcnt vmcnt(15) lgkmcnt(4)
    v_mfma_f32_32x32x16_bf16 v[32:47], v[92:95], v[72:75], v[32:47]
    v_mfma_f32_32x32x16_bf16 v[48:63], v[92:95], v[76:79], v[48:63]
    buffer_load_dwordx4 v[92:95], v6, s[64:67], s76 offen offset:1024 sc1
    ds_read_b128 v[72:75], v26 offset:0
    ds_read_b128 v[76:79], v14 offset:0
    s_waitcnt vmcnt(15) lgkmcnt(4)
    v_mfma_f32_32x32x16_bf16 v[32:47], v[96:99], v[80:83], v[32:47]
    v_mfma_f32_32x32x16_bf16 v[48:63], v[96:99], v[84:87], v[48:63]
    buffer_load_dwordx4 v[96:99], v6, s[64:67], s76 offen offset:2048 sc1
    ds_read_b128 v[80:83], v27 offset:0
    ds_read_b128 v[84:87], v15 offset:0
    s_waitcnt vmcnt(15) lgkmcnt(4)
    v_mfma_f32_32x32x16_bf16 v[32:47], v[100:103], v[64:67], v[32:47]
    v_mfma_f32_32x32x16_bf16 v[48:63], v[100:103], v[68:71], v[48:63]
    buffer_load_dwordx4 v[100:103], v6, s[64:67], s76 offen offset:3072 sc1
    ds_read_b128 v[64:67], v26 offset:8192
    ds_read_b128 v[68:71], v14 offset:8192
    s_waitcnt vmcnt(15) lgkmcnt(4)
    v_mfma_f32_32x32x16_bf16 v[32:47], v[104:107], v[72:75], v[32:47]
    v_mfma_f32_32x32x16_bf16 v[48:63], v[104:107], v[76:79], v[48:63]
    s_add_u32 s76, s76, 4096
    buffer_load_dwordx4 v[104:107], v6, s[64:67], s76 offen offset:0 sc1
    ds_read_b128 v[72:75], v27 offset:8192
    ds_read_b128 v[76:79], v15 offset:8192
    s_waitcnt vmcnt(15) lgkmcnt(4)
    v_mfma_f32_32x32x16_bf16 v[32:47], v[108:111], v[80:83], v[32:47]
    v_mfma_f32_32x32x16_bf16 v[48:63], v[108:111], v[84:87], v[48:63]
    buffer_load_dwordx4 v[108:111], v6, s[64:67], s76 offen offset:1024 sc1
    ds_read_b128 v[80:83], v24 offset:16384
    ds_read_b128 v[84:87], v12 offset:16384
    s_waitcnt vmcnt(15) lgkmcnt(4)
    v_mfma_f32_32x32x16_bf16 v[32:47], v[112:115], v[64:67], v[32:47]
    v_mfma_f32_32x32x16_bf16 v[48:63], v[112:115], v[68:71], v[48:63]
    buffer_load_dwordx4 v[112:115], v6, s[64:67], s76 offen offset:2048 sc1
    ds_read_b128 v[64:67], v25 offset:16384
    ds_read_b128 v[68:71], v13 offset:16384
    s_waitcnt vmcnt(15) lgkmcnt(4)
    v_mfma_f32_32x32x16_bf16 v[32:47], v[116:119], v[72:75], v[32:47]
    v_mfma_f32_32x32x16_bf16 v[48:63], v[116:119], v[76:79], v[48:63]
    buffer_load_dwordx4 v[116:119], v6, s[64:67], s76 offen offset:3072 sc1
    ds_read_b128 v[72:75], v24 offset:24576
    ds_read_b128 v[76:79], v12 offset:24576
    s_waitcnt vmcnt(15) lgkmcnt(4)
    v_mfma_f32_32x32x16_bf16 v[32:47], v[120:123], v[80:83], v[32:47]
    v_mfma_f32_32x32x16_bf16 v[48:63], v[120:123], v[84:87], v[48:63]
    s_add_u32 s76, s50, 384
    s_and_b32 s76, s76, 0x380
    s_lshl_b32 s76, s76, 6
    s_add_u32 s76, s76, s75
    buffer_load_dwordx4 v[120:123], v6, s[64:67], s76 offen offset:0 sc1
    ds_read_b128 v[80:83], v25 offset:24576
    ds_read_b128 v[84:87], v13 offset:24576
    s_waitcnt vmcnt(15) lgkmcnt(4)
    v_mfma_f32_32x32x16_bf16 v[32:47], v[124:127], v[64:67], v[32:47]
    v_mfma_f32_32x32x16_bf16 v[48:63], v[124:127], v[68:71], v[48:63]
    buffer_load_dwordx4 v[124:127], v6, s[64:67], s76 offen offset:1024 sc1
    ds_read_b128 v[64:67], v26 offset:16384
    ds_read_b128 v[68:71], v14 offset:16384
    s_waitcnt vmcnt(15) lgkmcnt(4)
    v_mfma_f32_32x32x16_bf16 v[32:47], v[128:131], v[72:75], v[32:47]
    v_mfma_f32_32x32x16_bf16 v[48:63], v[128:131], v[76:79], v[48:63]
    buffer_load_dwordx4 v[128:131], v6, s[64:67], s76 offen offset:2048 sc1
    ds_read_b128 v[72:75], v27 offset:16384
    ds_read_b128 v[76:79], v15 offset:16384
    s_waitcnt vmcnt(15) lgkmcnt(4)
    v_mfma_f32_32x32x16_bf16 v[32:47], v[132:135], v[80:83], v[32:47]
    v_mfma_f32_32x32x16_bf16 v[48:63], v[132:135], v[84:87], v[48:63]
    buffer_load_dwordx4 v[132:135], v6, s[64:67], s76 offen offset:3072 sc1
    ds_read_b128 v[80:83], v26 offset:24576
    ds_read_b128 v[84:87], v14 offset:24576
    s_waitcnt vmcnt(15) lgkmcnt(4)
    v_mfma_f32_32x32x16_bf16 v[32:47], v[136:139], v[64:67], v[32:47]
    v_mfma_f32_32x32x16_bf16 v[48:63], v[136:139], v[68:71], v[48:63]
    s_add_u32 s76, s76, 4096
    buffer_load_dwordx4 v[136:139], v6, s[64:67], s76 offen offset:0 sc1
    ds_read_b128 v[64:67], v27 offset:24576
    ds_read_b128 v[68:71], v15 offset:24576
    s_waitcnt vmcnt(15) lgkmcnt(4)
    v_mfma_f32_32x32x16_bf16 v[32:47], v[140:143], v[72:75], v[32:47]
    v_mfma_f32_32x32x16_bf16 v[48:63], v[140:143], v[76:79], v[48:63]
    buffer_load_dwordx4 v[140:143], v6, s[64:67], s76 offen offset:1024 sc1
    s_waitcnt vmcnt(15) lgkmcnt(2)
    v_mfma_f32_32x32x16_bf16 v[32:47], v[144:147], v[80:83], v[32:47]
    v_mfma_f32_32x32x16_bf16 v[48:63], v[144:147], v[84:87], v[48:63]
    buffer_load_dwordx4 v[144:147], v6, s[64:67], s76 offen offset:2048 sc1
    s_waitcnt vmcnt(15) lgkmcnt(0)
    v_mfma_f32_32x32x16_bf16 v[32:47], v[148:151], v[64:67], v[32:47]
    v_mfma_f32_32x32x16_bf16 v[48:63], v[148:151], v[68:71], v[48:63]
    s_mov_b64 exec, 1
    ds_add_u32 v20, v21 offset:16
    s_mov_b64 exec, -1
    buffer_load_dwordx4 v[148:151], v6, s[64:67], s76 offen offset:3072 sc1
    s_setprio 3
    s_mov_b32 s80, 262144
L_sb_47:
    ds_read_b32 v5, v20 offset:16
    s_waitcnt lgkmcnt(0)
    v_readfirstlane_b32 s72, v5
    s_nop 0
    s_cmp_ge_u32 s72, 16
    s_cbranch_scc1 L_sb_ok_48
    s_sleep 1
    s_sub_u32 s80, s80, 1
    s_cmp_lg_u32 s80, 0
    s_cbranch_scc1 L_sb_47
L_sb_ok_48:
    s_mov_b32 s51, s84
    s_add_u32 m0, s83, 0
    s_add_u32 s79, s51, 0
    buffer_load_dwordx4 v1, s[56:59], s79 offen  lds
    s_add_u32 m0, s83, 1024
    s_add_u32 s79, s51, 8192
    buffer_load_dwordx4 v7, s[56:59], s79 offen  lds
    s_add_u32 m0, s83, 8192
    s_add_u32 s79, s51, 0
    buffer_load_dwordx4 v1, s[60:63], s79 offen  lds
    s_add_u32 m0, s83, 9216
    s_add_u32 s79, s51, 8192
    buffer_load_dwordx4 v7, s[60:63], s79 offen  lds
    s_mov_b32 s68, s44
    s_mov_b32 s69, s45
    s_mov_b32 s70, 8388608
    s_mov_b32 s71, 0x20000
    s_lshl_b32 s76, s81, 15
    s_add_u32 s77, s76, 0
    buffer_load_ushort v152, v8, s[52:55], s77 offen offset:0
    buffer_load_ushort v153, v8, s[52:55], s77 offen offset:1024
    buffer_load_ushort v154, v8, s[52:55], s77 offen offset:2048
    buffer_load_ushort v155, v8, s[52:55], s77 offen offset:3072
    s_add_u32 s77, s76, 8192
    buffer_load_ushort v156, v8, s[52:55], s77 offen offset:0
    buffer_load_ushort v157, v8, s[52:55], s77 offen offset:1024
    buffer_load_ushort v158, v8, s[52:55], s77 offen offset:2048
    buffer_load_ushort v159, v8, s[52:55], s77 offen offset:3072
    s_add_u32 s77, s76, 16384
    buffer_load_ushort v160, v8, s[52:55], s77 offen offset:0
    buffer_load_ushort v161, v8, s[52:55], s77 offen offset:1024
    buffer_load_ushort v162, v8, s[52:55], s77 offen offset:2048
    buffer_load_ushort v163, v8, s[52:55], s77 offen offset:3072
    s_add_u32 s77, s76, 24576
    buffer_load_ushort v164, v8, s[52:55], s77 offen offset:0
    buffer_load_ushort v165, v8, s[52:55], s77 offen offset:1024
    buffer_load_ushort v166, v8, s[52:55], s77 offen offset:2048
    buffer_load_ushort v167, v8, s[52:55], s77 offen offset:3072
    s_lshl_b32 s81, s81, 17
    s_waitcnt vmcnt(16)
    s_add_u32 s16, s81, 0
    s_add_u32 s17, s81, 4096
    s_add_u32 s18, s81, 8192
    s_add_u32 s19, s81, 12288
    s_add_u32 s20, s81, 32768
    s_add_u32 s21, s81, 36864
    s_add_u32 s22, s81, 40960
    s_add_u32 s23, s81, 45056
    s_add_u32 s24, s81, 65536
    s_add_u32 s25, s81, 69632
    s_add_u32 s26, s81, 73728
    s_add_u32 s27, s81, 77824
    s_add_u32 s28, s81, 98304
    s_add_u32 s29, s81, 102400
    s_add_u32 s30, s81, 106496
    s_add_u32 s31, s81, 110592
    s_and_b32 s77, s13, 2
    s_lshl_b32 s77, s77, 1
    v_add_u32 v3, s77, v20
    s_mov_b64 exec, 1
    ds_add_u32 v20, v21 offset:16
    s_mov_b64 exec, -1
    s_mov_b32 s80, 262144
L_sb_49:
    ds_read_b32 v5, v20 offset:16
    s_waitcnt lgkmcnt(0)
    v_readfirstlane_b32 s72, v5
    s_nop 0
    s_cmp_ge_u32 s72, 20
    s_cbranch_scc1 L_sb_ok_50
    s_sleep 1
    s_sub_u32 s80, s80, 1
    s_cmp_lg_u32 s80, 0
    s_cbranch_scc1 L_sb_49
L_sb_ok_50:
    ds_read_b128 v[72:75], v24 offset:32768
    ds_read_b128 v[76:79], v12 offset:32768
    ds_read_b128 v[80:83], v25 offset:32768
    ds_read_b128 v[84:87], v13 offset:32768
    s_mov_b32 s80, 262144
L_lw_51:
    ds_read_b32 v5, v20 offset:24
    s_waitcnt lgkmcnt(0)
    v_readfirstlane_b32 s72, v5
    s_nop 0
    s_cmp_ge_u32 s72, 4
    s_cbranch_scc1 L_lw_ok_52
    s_sleep 2
    s_sub_u32 s80, s80, 1
    s_cmp_lg_u32 s80, 0
    s_cbranch_scc1 L_lw_51
L_lw_ok_52:
    s_mov_b32 s80, 262144
L_lw_53:
    ds_read_b32 v5, v2 offset:48
    s_waitcnt lgkmcnt(0)
    v_readfirstlane_b32 s72, v5
    s_nop 0
    s_cmp_ge_u32 s72, 9
    s_cbranch_scc1 L_lw_ok_54
    s_sleep 1
    s_sub_u32 s80, s80, 1
    s_cmp_lg_u32 s80, 0
    s_cbranch_scc1 L_lw_53
L_lw_ok_54:
    ds_read_b128 v[64:67], v24 offset:40960
    ds_read_b128 v[68:71], v12 offset:40960
    s_waitcnt lgkmcnt(4)
    v_mfma_f32_32x32x16_bf16 v[32:47], v[88:91], v[72:75], v[32:47]
    v_mfma_f32_32x32x16_bf16 v[48:63], v[88:91], v[76:79], v[48:63]
    ds_read_b128 v[72:75], v25 offset:40960
    ds_read_b128 v[76:79], v13 offset:40960
    s_waitcnt lgkmcnt(4)
    v_mfma_f32_32x32x16_bf16 v[32:47], v[92:95], v[80:83], v[32:47]
    v_mfma_f32_32x32x16_bf16 v[48:63], v[92:95], v[84:87], v[48:63]
    ds_read_b128 v[80:83], v26 offset:32768
    ds_read_b128 v[84:87], v14 offset:32768
    s_waitcnt lgkmcnt(4)
    v_mfma_f32_32x32x16_bf16 v[32:47], v[96:99], v[64:67], v[32:47]
    v_mfma_f32_32x32x16_bf16 v[48:63], v[96:99], v[68:71], v[48:63]
    ds_read_b128 v[64:67], v27 offset:32768
    ds_read_b128 v[68:71], v15 offset:32768
    s_waitcnt lgkmcnt(4)
    v_mfma_f32_32x32x16_bf16 v[32:47], v[100:103], v[72:75], v[32:47]
    v_mfma_f32_32x32x16_bf16 v[48:63], v[100:103], v[76:79], v[48:63]
    ds_read_b128 v[72:75], v26 offset:40960
    ds_read_b128 v[76:79], v14 offset:40960
    s_waitcnt lgkmcnt(4)
    v_mfma_f32_32x32x16_bf16 v[32:47], v[104:107], v[80:83], v[32:47]
    v_mfma_f32_32x32x16_bf16 v[48:63], v[104:107], v[84:87], v[48:63]
    ds_read_b128 v[80:83], v27 offset:40960
    ds_read_b128 v[84:87], v15 offset:40960
    s_waitcnt lgkmcnt(4)
    v_mfma_f32_32x32x16_bf16 v[32:47], v[108:111], v[64:67], v[32:47]
    v_mfma_f32_32x32x16_bf16 v[48:63], v[108:111], v[68:71], v[48:63]
    ds_read_b128 v[64:67], v28 offset:0
    ds_read_b128 v[68:71], v16 offset:0
    s_waitcnt lgkmcnt(4)
    v_mfma_f32_32x32x16_bf16 v[32:47], v[112:115], v[72:75], v[32:47]
    v_mfma_f32_32x32x16_bf16 v[48:63], v[112:115], v[76:79], v[48:63]
    ds_read_b128 v[72:75], v29 offset:0
    ds_read_b128 v[76:79], v17 offset:0
    s_waitcnt lgkmcnt(4)
    v_mfma_f32_32x32x16_bf16 v[32:47], v[116:119], v[80:83], v[32:47]
    v_mfma_f32_32x32x16_bf16 v[48:63], v[116:119], v[84:87], v[48:63]
    ds_read_b128 v[80:83], v28 offset:8192
    ds_read_b128 v[84:87], v16 offset:8192
    s_waitcnt lgkmcnt(4)
    v_mfma_f32_32x32x16_bf16 v[32:47], v[120:123], v[64:67], v[32:47]
    v_mfma_f32_32x32x16_bf16 v[48:63], v[120:123], v[68:71], v[48:63]
    ds_read_b128 v[64:67], v29 offset:8192
    ds_read_b128 v[68:71], v17 offset:8192
    s_waitcnt lgkmcnt(4)
    v_mfma_f32_32x32x16_bf16 v[32:47], v[124:127], v[72:75], v[32:47]
    v_mfma_f32_32x32x16_bf16 v[48:63], v[124:127], v[76:79], v[48:63]
    ds_read_b128 v[72:75], v30 offset:0
    ds_read_b128 v[76:79], v18 offset:0
    s_waitcnt lgkmcnt(4)
    v_mfma_f32_32x32x16_bf16 v[32:47], v[128:131], v[80:83], v[32:47]
    v_mfma_f32_32x32x16_bf16 v[48:63], v[128:131], v[84:87], v[48:63]
    ds_read_b128 v[80:83], v31 offset:0
    ds_read_b128 v[84:87], v19 offset:0
    s_waitcnt lgkmcnt(4)
    v_mfma_f32_32x32x16_bf16 v[32:47], v[132:135], v[64:67], v[32:47]
    v_mfma_f32_32x32x16_bf16 v[48:63], v[132:135], v[68:71], v[48:63]
    ds_read_b128 v[64:67], v30 offset:8192
    ds_read_b128 v[68:71], v18 offset:8192
    s_waitcnt lgkmcnt(4)
    v_mfma_f32_32x32x16_bf16 v[32:47], v[136:139], v[72:75], v[32:47]
    v_mfma_f32_32x32x16_bf16 v[48:63], v[136:139], v[76:79], v[48:63]
    ds_read_b128 v[72:75], v31 offset:8192
    ds_read_b128 v[76:79], v19 offset:8192
    s_waitcnt lgkmcnt(4)
    v_mfma_f32_32x32x16_bf16 v[32:47], v[140:143], v[80:83], v[32:47]
    v_mfma_f32_32x32x16_bf16 v[48:63], v[140:143], v[84:87], v[48:63]
    s_waitcnt lgkmcnt(2)
    v_mfma_f32_32x32x16_bf16 v[32:47], v[144:147], v[64:67], v[32:47]
    v_mfma_f32_32x32x16_bf16 v[48:63], v[144:147], v[68:71], v[48:63]
    s_waitcnt lgkmcnt(0)
    v_mfma_f32_32x32x16_bf16 v[32:47], v[148:151], v[72:75], v[32:47]
    v_mfma_f32_32x32x16_bf16 v[48:63], v[148:151], v[76:79], v[48:63]
    s_nop 11
    ds_write_b128 v11, v[48:51] offset:0
    ds_write_b128 v11, v[52:55] offset:1024
    ds_write_b128 v11, v[56:59] offset:2048
    ds_write_b128 v11, v[60:63] offset:3072
    s_mov_b64 exec, 1
    ds_add_u32 v3, v21 offset:76
    s_mov_b64 exec, -1
    s_waitcnt vmcnt(0)
    v_dot2c_f32_bf16 v32, v152, v9
    v_dot2c_f32_bf16 v33, v153, v9
    v_dot2c_f32_bf16 v34, v154, v9
    v_dot2c_f32_bf16 v35, v155, v9
    v_dot2c_f32_bf16 v36, v156, v9
    v_dot2c_f32_bf16 v37, v157, v9
    v_dot2c_f32_bf16 v38, v158, v9
    v_dot2c_f32_bf16 v39, v159, v9
    v_dot2c_f32_bf16 v40, v160, v9
    v_dot2c_f32_bf16 v41, v161, v9
    v_dot2c_f32_bf16 v42, v162, v9
    v_dot2c_f32_bf16 v43, v163, v9
    v_dot2c_f32_bf16 v44, v164, v9
    v_dot2c_f32_bf16 v45, v165, v9
    v_dot2c_f32_bf16 v46, v166, v9
    v_dot2c_f32_bf16 v47, v167, v9
    s_mov_b32 s80, 262144
L_lw_55:
    ds_read_b32 v5, v3 offset:76
    s_waitcnt lgkmcnt(0)
    v_readfirstlane_b32 s72, v5
    s_nop 0
    s_cmp_ge_u32 s72, 2
    s_cbranch_scc1 L_lw_ok_56
    s_sub_u32 s80, s80, 1
    s_cmp_lg_u32 s80, 0
    s_cbranch_scc1 L_lw_55
L_lw_ok_56:
    ds_read_b128 v[48:51], v4 offset:0
    ds_read_b128 v[52:55], v4 offset:1024
    ds_read_b128 v[56:59], v4 offset:2048
    ds_read_b128 v[60:63], v4 offset:3072
    s_waitcnt lgkmcnt(0)
    v_pk_add_f32 v[32:33], v[32:33], v[48:49]
    v_pk_add_f32 v[34:35], v[34:35], v[50:51]
    v_pk_add_f32 v[36:37], v[36:37], v[52:53]
    v_pk_add_f32 v[38:39], v[38:39], v[54:55]
    v_pk_add_f32 v[40:41], v[40:41], v[56:57]
    v_pk_add_f32 v[42:43], v[42:43], v[58:59]
    v_pk_add_f32 v[44:45], v[44:45], v[60:61]
    v_pk_add_f32 v[46:47], v[46:47], v[62:63]
    buffer_store_dword v32, v10, s[68:71], s16 offen sc1
    buffer_store_dword v33, v10, s[68:71], s17 offen sc1
    buffer_store_dword v34, v10, s[68:71], s18 offen sc1
    buffer_store_dword v35, v10, s[68:71], s19 offen sc1
    buffer_store_dword v36, v10, s[68:71], s20 offen sc1
    buffer_store_dword v37, v10, s[68:71], s21 offen sc1
    buffer_store_dword v38, v10, s[68:71], s22 offen sc1
    buffer_store_dword v39, v10, s[68:71], s23 offen sc1
    buffer_store_dword v40, v10, s[68:71], s24 offen sc1
    buffer_store_dword v41, v10, s[68:71], s25 offen sc1
    buffer_store_dword v42, v10, s[68:71], s26 offen sc1
    buffer_store_dword v43, v10, s[68:71], s27 offen sc1
    buffer_store_dword v44, v10, s[68:71], s28 offen sc1
    buffer_store_dword v45, v10, s[68:71], s29 offen sc1
    buffer_store_dword v46, v10, s[68:71], s30 offen sc1
    buffer_store_dword v47, v10, s[68:71], s31 offen sc1
L_s_fin:
    s_endpgm
L_fb:
    s_lshl_b32 s76, s3, 10
    s_add_u32 s76, s76, 155648
    v_add_u32 v6, s76, v1
    ds_read_b128 v[76:79], v6
    v_mov_b32 v3, 0xff800000
    s_mov_b32 s76, 262144
L_fb_a:
    buffer_load_dwordx4 v[56:59], v1, s[64:67], s76 offen sc1
    s_waitcnt vmcnt(0) lgkmcnt(0)
    v_mfma_f32_32x32x16_bf16 v[8:23], v[56:59], v[76:79], 0
    s_nop 11
    v_max3_f32 v3, v3, v8, v9
    v_max3_f32 v3, v3, v10, v11
    v_max3_f32 v3, v3, v12, v13
    v_max3_f32 v3, v3, v14, v15
    v_max3_f32 v3, v3, v16, v17
    v_max3_f32 v3, v3, v18, v19
    v_max3_f32 v3, v3, v20, v21
    v_max3_f32 v3, v3, v22, v23
    s_add_u32 s76, s76, 1024
    s_cmp_lt_u32 s76, 327680
    s_cbranch_scc1 L_fb_a
    v_mov_b32 v6, v3
    s_nop 1
    v_permlane32_swap_b32 v6, v3
    s_nop 1
    v_max_f32 v3, v3, v6
    v_sub_f32 v24, 0, v3
    v_mov_b32 v40, 0
    v_sub_f32 v25, 0, v3
    v_mov_b32 v41, 0
    v_sub_f32 v26, 0, v3
    v_mov_b32 v42, 0
    v_sub_f32 v27, 0, v3
    v_mov_b32 v43, 0
    v_sub_f32 v28, 0, v3
    v_mov_b32 v44, 0
    v_sub_f32 v29, 0, v3
    v_mov_b32 v45, 0
    v_sub_f32 v30, 0, v3
    v_mov_b32 v46, 0
    v_sub_f32 v31, 0, v3
    v_mov_b32 v47, 0
    v_sub_f32 v32, 0, v3
    v_mov_b32 v48, 0
    v_sub_f32 v33, 0, v3
    v_mov_b32 v49, 0
    v_sub_f32 v34, 0, v3
    v_mov_b32 v50, 0
    v_sub_f32 v35, 0, v3
    v_mov_b32 v51, 0
    v_sub_f32 v36, 0, v3
    v_mov_b32 v52, 0
    v_sub_f32 v37, 0, v3
    v_mov_b32 v53, 0
    v_sub_f32 v38, 0, v3
    v_mov_b32 v54, 0
    v_sub_f32 v39, 0, v3
    v_mov_b32 v55, 0
    s_mov_b32 s76, 262144
    s_mov_b32 s77, 327680
L_fb_b:
    buffer_load_dwordx4 v[56:59], v1, s[64:67], s76 offen sc1
    buffer_load_dwordx4 v[60:63], v1, s[64:67], s77 offen sc1
    v_mov_b32 v64, 0x3f803f80
    v_mov_b32 v65, 0x3f803f80
    v_mov_b32 v66, 0x3f803f80
    v_mov_b32 v67, 0x3f803f80
    s_waitcnt vmcnt(0)
    v_permlane16_swap_b32 v60, v64
    v_permlane16_swap_b32 v61, v65
    v_permlane16_swap_b32 v62, v66
    v_permlane16_swap_b32 v63, v67
    v_mfma_f32_32x32x16_bf16 v[8:23], v[56:59], v[76:79], v[24:39]
    s_nop 11
    v_exp_f32 v8, v8
    v_exp_f32 v9, v9
    v_exp_f32 v10, v10
    v_exp_f32 v11, v11
    v_exp_f32 v12, v12
    v_exp_f32 v13, v13
    v_exp_f32 v14, v14
    v_exp_f32 v15, v15
    v_exp_f32 v16, v16
    v_exp_f32 v17, v17
    v_exp_f32 v18, v18
    v_exp_f32 v19, v19
    v_exp_f32 v20, v20
    v_exp_f32 v21, v21
    v_exp_f32 v22, v22
    v_exp_f32 v23, v23
    v_cvt_pk_bf16_f32 v68, v8, v9
    v_cvt_pk_bf16_f32 v69, v10, v11
    v_cvt_pk_bf16_f32 v70, v12, v13
    v_cvt_pk_bf16_f32 v71, v14, v15
    v_cvt_pk_bf16_f32 v72, v16, v17
    v_cvt_pk_bf16_f32 v73, v18, v19
    v_cvt_pk_bf16_f32 v74, v20, v21
    v_cvt_pk_bf16_f32 v75, v22, v23
    s_nop 1
    v_mfma_f32_32x32x16_bf16 v[40:55], v[60:63], v[68:71], v[40:55]
    v_mfma_f32_32x32x16_bf16 v[40:55], v[64:67], v[72:75], v[40:55]
    s_add_u32 s76, s76, 1024
    s_add_u32 s77, s77, 1024
    s_cmp_lt_u32 s76, 327680
    s_cbranch_scc1 L_fb_b
    s_nop 11
    v_mov_b32 v104, v40
    v_mov_b32 v105, v41
    v_mov_b32 v106, v42
    v_mov_b32 v107, v43
    v_mov_b32 v108, v44
    v_mov_b32 v109, v45
    v_mov_b32 v110, v46
    v_mov_b32 v111, v47
    v_mov_b32 v112, v48
    v_rcp_f32 v114, v48
    s_nop 0
    s_branch L_norm_fin
.section .rodata,"a"
.p2align 6
.amdhsa_kernel concat_heads__ssm_conv_s5__grouped_kv_mqa__prompt_kernel
  .amdhsa_next_free_vgpr 168
  .amdhsa_next_free_sgpr 102
  .amdhsa_accum_offset 168
  .amdhsa_group_segment_fixed_size 0
  .amdhsa_kernarg_size 136
  .amdhsa_user_sgpr_count 2
  .amdhsa_user_sgpr_kernarg_segment_ptr 1
  .amdhsa_system_sgpr_workgroup_id_x 1
.end_amdhsa_kernel
```
